```python
import torch

def _softmax(x, axis=-1):
    return torch.softmax(x, dim=axis)
def _gelu(x):
    return torch.nn.functional.gelu(x, approximate="tanh")
def _silu(x):
    return torch.nn.functional.silu(x)
def _sigmoid(x):
    return torch.sigmoid(x)
def _layernorm(x, axis=-1, eps=1e-5):
    m = x.mean(dim=axis, keepdim=True)
    v = x.var(dim=axis, keepdim=True, unbiased=False)
    return (x - m) / torch.sqrt(v + eps)
def _scatter_add(tgt, idx, src, axis=0):
    return tgt.clone().index_add_(axis, idx, src)
def _segment_sum(src, seg, n):
    out = torch.zeros((n,) + src.shape[1:], dtype=src.dtype)
    return out.index_add_(0, seg, src)
def _pad(x, pw):
    flat = tuple(v for pair in reversed(pw) for v in pair)
    return torch.nn.functional.pad(x, flat)

kernel_name = 'gated_mix__ssm_conv_s4d__dense_activation_squared_relu__prompt'

def setup_inputs():

    _w = (lambda a: (lambda t: t.to(torch.bfloat16) if t.is_floating_point() else t)(torch.as_tensor(a)))
    def _A_setup():
        Bsz, L, D, N = 1, 2048, 448, 256
        return {
            "u": _w((lambda *s: torch.randn(*s, dtype=torch.bfloat16) * 0.05)(Bsz, L, D)),
            "log_A_real": _w((lambda *s: torch.randn(*s, dtype=torch.bfloat16) * 3.2)(D, N) * 0.5),
            "A_imag": _w((lambda *s: torch.randn(*s, dtype=torch.bfloat16) * 0.1)(D, N) * 3.14),
            "C_real": _w((lambda *s: torch.randn(*s, dtype=torch.bfloat16) * 0.8)(D, N) / N ** 0.5),
            "C_imag": _w((lambda *s: torch.randn(*s, dtype=torch.bfloat16) * 0.8)(D, N) / N ** 0.5),
            "log_dt": _w((lambda *s: torch.randn(*s, dtype=torch.bfloat16) * 0.1)(D) * 0.5 - 4.0),
            "D_skip": _w((lambda *s: torch.randn(*s, dtype=torch.bfloat16) * 0.1)(D)),
        }
    _A_in = _A_setup()

    def _B_setup():
        B, S, D, F = 1, 2048, 448, 1792
        return {
            "x": _w((lambda *s: torch.randn(*s, dtype=torch.bfloat16) * 0.05)(B, S, D)),
            "w1": _w((lambda *s: torch.randn(*s, dtype=torch.bfloat16) * 0.05)(D, F)),
            "b1": _w((lambda *s: torch.randn(*s, dtype=torch.bfloat16) * 0.05)(F)),
            "w2": _w((lambda *s: torch.randn(*s, dtype=torch.bfloat16) * 0.05)(F, D)),
            "b2": _w((lambda *s: torch.randn(*s, dtype=torch.bfloat16) * 0.05)(D)),
        }
    _B_in = _B_setup()

    return {
        "A_u": _A_in["u"],
        "A_log_A_real": _A_in["log_A_real"],
        "A_A_imag": _A_in["A_imag"],
        "A_C_real": _A_in["C_real"],
        "A_C_imag": _A_in["C_imag"],
        "A_log_dt": _A_in["log_dt"],
        "A_D_skip": _A_in["D_skip"],
        "B_x": _B_in["x"],
        "B_w1": _B_in["w1"],
        "B_b1": _B_in["b1"],
        "B_w2": _B_in["w2"],
        "B_b2": _B_in["b2"],
        "gate_w": _w((lambda *s: torch.randn(*s, dtype=torch.bfloat16) * 0.05)(448) * 16.0),
    }

def reference(A_u, A_log_A_real, A_A_imag, A_C_real, A_C_imag, A_log_dt, A_D_skip, B_x, B_w1, B_b1, B_w2, B_b2, gate_w):
    def _A_ref(u, log_A_real, A_imag, C_real, C_imag, log_dt, D_skip):
        L = u.shape[1]
        dt = torch.exp(log_dt)
        A = -torch.exp(log_A_real) + 1j * A_imag
        C = (C_real + 1j * C_imag) * dt[:, None]
        pos = (lambda x, dt: x.to(dt))(torch.arange(L), log_dt.dtype)
        P = torch.exp((A * dt[:, None])[:, :, None] * pos[None, None, :])
        K = 2.0 * torch.einsum("dn,dnl->dl", C, P).real
        L2 = 2 * L
        u_t = (lambda x, *d: x.permute(*d))(u, 0, 2, 1)
        Kf = (lambda x, *a, **k: torch.fft.rfft(x.float(), *a, **k))(K, L2)
        Uf = (lambda x, *a, **k: torch.fft.rfft(x.float(), *a, **k))(u_t, L2)
        y = (lambda x, *a, **k: torch.fft.irfft(x, *a, **k).to(torch.bfloat16))(Uf * Kf[None, :, :], L2)[:, :, :L]
        y = (lambda x, *d: x.permute(*d))(y, 0, 2, 1)
        return y + u * D_skip[None, None, :]

    def _B_ref(x, w1, b1, w2, b2):
        h = torch.einsum("bsd,df->bsf", x, w1) + b1
        zero = torch.zeros_like(h)
        r = torch.where(h > zero, h, zero)
        h = r * r
        out = torch.einsum("bsf,fd->bsd", h, w2) + b2
        return out

    x = A_u
    g = _sigmoid((x * gate_w).sum(-1, keepdims=True))
    a = _A_ref(x, A_log_A_real, A_A_imag, A_C_real, A_C_imag, A_log_dt, A_D_skip)
    b = _B_ref(x, B_w1, B_b1, B_w2, B_b2)
    return g * a + (1 - g) * b
```

```asm
; @launch grid=(256,1,1) block=(256,1,1) lds=163840
.amdgcn_target "amdgcn-amd-amdhsa--gfx950"
.text
.globl gated_mix__ssm_conv_s4d__dense_activation_squared_relu__prompt_kernel
.p2align 8
.type gated_mix__ssm_conv_s4d__dense_activation_squared_relu__prompt_kernel,@function
gated_mix__ssm_conv_s4d__dense_activation_squared_relu__prompt_kernel:
    s_load_dwordx16 s[4:19], s[0:1], 0
    s_load_dwordx16 s[20:35], s[0:1], 64
    s_getpc_b64 s[36:37]
    v_lshlrev_b32 v2, 7, v0
    global_load_dword v255, v2, s[36:37]
    s_sub_u32 s2, s2, 32
    s_cmpk_ge_u32 s2, 224
    s_cbranch_scc1 L_other
    s_andn2_b32 s67, s2, 31
    s_add_u32 s62, s2, s67
    s_lshl_b32 s67, s62, 9
    v_lshrrev_b32 v3, 7, v0
    v_mul_u32_u24 v3, 15872, v3
    v_lshl_add_u32 v3, v0, 2, v3
    v_add_u32 v3, s67, v3
    v_lshrrev_b32 v62, 8, v3
    v_and_b32 v62, -2, v62
    s_waitcnt lgkmcnt(0)
    global_load_ushort v38, v62, s[14:15]
    global_load_dword v34, v3, s[6:7]
    global_load_dword v35, v3, s[8:9]
    global_load_dword v36, v3, s[10:11]
    global_load_dword v37, v3, s[12:13]
    v_lshrrev_b32 v2, 6, v0
    v_and_b32 v1, 63, v0
    v_readfirstlane_b32 s56, v2
    s_and_b32 s67, s2, 7
    s_lshr_b32 s68, s2, 3
    s_mul_i32 s69, s68, 37
    s_lshr_b32 s69, s69, 8
    s_mul_i32 s70, s69, 7
    s_sub_u32 s60, s68, s70
    s_lshr_b32 s70, s67, 1
    s_lshl2_add_u32 s57, s70, s69
    s_lshl1_add_u32 s61, s69, s60
    s_cmp_ge_u32 s61, 7
    s_cselect_b32 s70, 7, 0
    s_sub_u32 s61, s61, s70
    s_lshl_b32 s63, s61, 7
    s_lshl_b32 s65, s56, 12
    s_add_u32 m0, s65, 512
    v_lshrrev_b32 v2, 3, v1
    v_lshrrev_b32 v3, 4, v1
    v_and_b32 v63, 7, v1
    v_xor_b32 v63, v63, v3
    s_lshl2_add_u32 s70, s57, s56
    s_mul_i32 s70, s70, 28672
    v_mul_u32_u24 v2, 896, v2
    v_add_u32 v2, s70, v2
    v_lshl_add_u32 v4, v63, 4, v2
    v_xor_b32 v63, 4, v63
    v_lshl_add_u32 v5, v63, 4, v2
    s_mov_b64 s[36:37], s[4:5]
    s_mov_b32 s38, 1835008
    s_mov_b32 s39, 0x00020000
    v_add_u32 v5, 6144, v5
    v_add_u32 v6, 12288, v4
    v_add_u32 v7, 12288, v5
    buffer_load_dwordx4 v4, s[36:39], s63 offen offset:0 lds
    buffer_load_dwordx4 v5, s[36:39], s63 offen offset:1024 lds
    s_lshl2_add_u32 s59, s67, s69
    s_and_b32 s70, s67, 1
    s_mul_i32 s70, s70, 7
    s_add_u32 s58, s70, s60
    s_mul_i32 s64, s61, 229376
    v_and_b32 v63, 15, v1
    v_lshlrev_b32 v2, 2, v3
    v_xor_b32 v63, v63, v2
    s_mul_i32 s67, s56, 57344
    s_lshl_b32 s68, s58, 8
    buffer_load_dwordx4 v6, s[36:39], s63 offen offset:2048 lds
    s_add_u32 s67, s67, s68
    v_mul_u32_u24 v3, 3584, v3
    v_add_u32 v3, s67, v3
    v_lshl_add_u32 v8, v63, 4, v3
    s_mov_b64 s[40:41], s[20:21]
    s_mov_b32 s42, 1605632
    s_mov_b32 s43, 0x00020000
    v_add_u32 v9, 13312, v8
    v_add_u32 v10, 26624, v8
    v_add_u32 v11, 39936, v8
    buffer_load_dwordx4 v7, s[36:39], s63 offen offset:3072 lds
    s_add_u32 m0, s65, 16896
    s_nop 0
    buffer_load_dwordx4 v8, s[40:43], s64 offen offset:0 lds
    buffer_load_dwordx4 v9, s[40:43], s64 offen offset:1024 lds
    s_lshr_b32 s67, s56, 1
    s_lshl_b32 s67, s67, 7
    s_add_u32 s67, s67, s68
    buffer_load_dwordx4 v10, s[40:43], s64 offen offset:2048 lds
    v_and_b32 v2, 31, v1
    v_lshl_add_u32 v3, v2, 1, s67
    buffer_load_dwordx4 v11, s[40:43], s64 offen offset:3072 lds
    s_add_u32 m0, s65, 33280
    s_add_u32 s63, s63, 128
    s_add_u32 s64, s64, 229376
    s_cmpk_eq_u32 s63, 896
    s_cselect_b32 s63, 0, s63
    s_cselect_b32 s64, 0, s64
    global_load_ushort v24, v3, s[22:23]
    global_load_ushort v26, v3, s[22:23] offset:64
    global_load_ushort v39, v62, s[16:17]
    s_mov_b32 s71, 1069066811
    s_mul_i32 s67, s56, 13568
    s_add_u32 s67, s67, 98816
    v_lshrrev_b32 v3, 2, v1
    v_mul_u32_u24 v3, 848, v3
    v_and_b32 v62, 3, v1
    v_lshl_add_u32 v3, v62, 2, v3
    v_add_u32 v40, s67, v3
    v_lshrrev_b32 v3, 5, v1
    v_mul_u32_u24 v63, 848, v3
    v_lshl_add_u32 v63, v2, 4, v63
    v_add_u32 v41, s67, v63
    v_bfe_u32 v63, v1, 1, 3
    v_xor_b32 v63, v63, v3
    s_and_b32 s67, s56, 1
    s_lshl_b32 s67, s67, 13
    s_add_u32 s67, s67, 512
    v_lshl_add_u32 v2, v2, 7, s67
    v_lshl_add_u32 v12, v63, 4, v2
    v_xor_b32 v13, 32, v12
    v_xor_b32 v14, 64, v12
    v_xor_b32 v15, 96, v12
    v_bfe_u32 v63, v1, 2, 2
    v_lshl_add_u32 v2, v3, 3, v63
    v_lshlrev_b32 v2, 8, v2
    s_and_b32 s67, s56, 2
    v_xor_b32 v63, s67, v63
    v_lshl_add_u32 v2, v63, 6, v2
    v_bfe_u32 v63, v1, 4, 1
    v_lshl_add_u32 v2, v63, 5, v2
    v_lshl_add_u32 v2, v62, 3, v2
    v_add_u32 v20, 16896, v2
    v_xor_b32 v21, 64, v20
    v_mov_b32 v25, 0
    v_mov_b32 v27, 0
    v_mov_b32 v28, 0
    v_mov_b32 v29, 0
    v_sub_u32 v30, 1, v3
    v_mul_u32_u24 v30, 0x3f80, v30
    v_mov_b32 v31, 0
    v_mov_b32 v32, 0
    v_mov_b32 v33, 0
    v_add_u32 v16, 65536, v12
    v_add_u32 v17, 65536, v13
    v_add_u32 v18, 65536, v14
    v_add_u32 v19, 65536, v15
    v_add_u32 v22, 65536, v20
    v_add_u32 v23, 65536, v21
    v_and_b32 v2, 31, v1
    v_and_b32 v3, 7, v1
    v_mul_u32_u24 v178, 292, v3
    v_mul_u32_u24 v62, 584, v3
    v_add_u32 v62, 32, v62
    v_cmp_lt_u32 vcc, 7, v2
    v_and_b32 v63, 1, v1
    v_mul_u32_u24 v63, 1168, v63
    v_cndmask_b32 v178, v178, v62, vcc
    v_bfe_u32 v62, v1, 1, 1
    v_lshl_add_u32 v63, v62, 5, v63
    v_cmp_lt_u32 vcc, 11, v2
    v_add_u32 v63, 64, v63
    v_lshlrev_b32 v62, 5, v3
    v_cndmask_b32 v178, v178, v63, vcc
    v_cmp_lt_u32 vcc, 15, v2
    v_add_u32 v62, 128, v62
    v_lshrrev_b32 v63, 5, v1
    v_cndmask_b32 v178, v178, v62, vcc
    v_lshl_add_u32 v178, v63, 2, v178
    s_mul_i32 s67, s56, 13568
    s_add_u32 s67, s67, 98816
    v_lshl_add_u32 v178, v178, 2, s67
    v_lshlrev_b32 v2, 3, v0
    v_sub_u32 v2, 2047, v2
    v_cvt_f32_u32 v2, v2
    s_movk_i32 s67, 24704
    v_add_f32 v3, 0x80000000, v2
    v_add_f32 v62, 0xbf800000, v2
    v_cvt_pk_bf16_f32 v3, v3, v62
    v_and_b32 v62, 0xffff0000, v3
    v_lshlrev_b32 v3, 16, v3
    v_cvt_u32_f32 v62, v62
    v_cvt_u32_f32 v3, v3
    v_and_b32 v171, 7, v62
    v_and_b32 v170, 7, v3
    v_lshrrev_b32 v62, 3, v62
    v_lshrrev_b32 v3, 3, v3
    v_mul_u32_u24 v171, 292, v171
    v_mul_u32_u24 v170, 292, v170
    v_add3_u32 v171, v171, v62, s67
    v_add3_u32 v170, v170, v3, s67
    v_lshlrev_b32 v171, 2, v171
    v_lshlrev_b32 v170, 2, v170
    v_add_f32 v3, 0xc0000000, v2
    v_add_f32 v62, 0xc0400000, v2
    v_cvt_pk_bf16_f32 v3, v3, v62
    v_and_b32 v62, 0xffff0000, v3
    v_lshlrev_b32 v3, 16, v3
    v_cvt_u32_f32 v62, v62
    v_cvt_u32_f32 v3, v3
    v_and_b32 v173, 7, v62
    v_and_b32 v172, 7, v3
    v_lshrrev_b32 v62, 3, v62
    v_lshrrev_b32 v3, 3, v3
    v_mul_u32_u24 v173, 292, v173
    v_mul_u32_u24 v172, 292, v172
    v_add3_u32 v173, v173, v62, s67
    buffer_load_dwordx4 v4, s[36:39], s63 offen offset:0 lds
    v_add3_u32 v172, v172, v3, s67
    v_lshlrev_b32 v173, 2, v173
    v_lshlrev_b32 v172, 2, v172
    v_add_f32 v3, 0xc0800000, v2
    v_add_f32 v62, 0xc0a00000, v2
    v_cvt_pk_bf16_f32 v3, v3, v62
    v_and_b32 v62, 0xffff0000, v3
    v_lshlrev_b32 v3, 16, v3
    v_cvt_u32_f32 v62, v62
    v_cvt_u32_f32 v3, v3
    v_and_b32 v175, 7, v62
    v_and_b32 v174, 7, v3
    v_lshrrev_b32 v62, 3, v62
    v_lshrrev_b32 v3, 3, v3
    v_mul_u32_u24 v175, 292, v175
    v_mul_u32_u24 v174, 292, v174
    buffer_load_dwordx4 v5, s[36:39], s63 offen offset:1024 lds
    v_add3_u32 v175, v175, v62, s67
    v_add3_u32 v174, v174, v3, s67
    v_lshlrev_b32 v175, 2, v175
    v_lshlrev_b32 v174, 2, v174
    v_add_f32 v3, 0xc0c00000, v2
    v_add_f32 v62, 0xc0e00000, v2
    v_cvt_pk_bf16_f32 v3, v3, v62
    v_and_b32 v62, 0xffff0000, v3
    v_lshlrev_b32 v3, 16, v3
    v_cvt_u32_f32 v62, v62
    v_cvt_u32_f32 v3, v3
    v_and_b32 v177, 7, v62
    v_and_b32 v176, 7, v3
    v_lshrrev_b32 v62, 3, v62
    v_lshrrev_b32 v3, 3, v3
    v_mul_u32_u24 v177, 292, v177
    buffer_load_dwordx4 v6, s[36:39], s63 offen offset:2048 lds
    v_mul_u32_u24 v176, 292, v176
    v_add3_u32 v177, v177, v62, s67
    v_add3_u32 v176, v176, v3, s67
    v_lshlrev_b32 v177, 2, v177
    v_lshlrev_b32 v176, 2, v176
    v_lshrrev_b32 v2, 3, v1
    v_mul_u32_u24 v2, 896, v2
    v_bfe_u32 v3, v1, 4, 1
    v_lshlrev_b32 v3, 2, v3
    v_and_b32 v62, 7, v1
    v_xor_b32 v3, v3, v62
    v_lshl_add_u32 v236, v3, 4, v2
    v_add_u32 v237, 6144, v236
    v_add_u32 v238, 12288, v236
    v_add_u32 v239, 18432, v236
    s_mul_i32 s18, s56, 401408
    s_lshl_b32 s67, s60, 7
    s_add_u32 s18, s18, s67
    s_mov_b64 s[44:45], s[24:25]
    s_mov_b32 s46, 1605632
    s_mov_b32 s47, 0x00020000
    s_add_u32 s11, s60, 4
    s_cmp_ge_u32 s11, 7
    s_cselect_b32 s12, 7, 0
    s_sub_u32 s11, s11, s12
    s_mul_i32 s11, s11, 57344
    s_add_u32 s11, s11, s18
    s_add_u32 s12, s11, 28672
    s_waitcnt vmcnt(18)
    v_lshlrev_b32 v2, 16, v38
    v_mul_f32 v3, s71, v2
    v_fma_f32 v62, v2, s71, -v3
    v_fmac_f32 v62, 0x32a57060, v2
    v_exp_f32 v3, v3
    v_mul_f32 v62, 0x3f317218, v62
    v_fmac_f32 v3, v3, v62
    v_cvt_pk_bf16_f32 v3, v3, v3
    v_lshlrev_b32 v38, 16, v3
    s_waitcnt vmcnt(17)
    v_lshlrev_b32 v56, 16, v34
    buffer_load_dwordx4 v7, s[36:39], s63 offen offset:3072 lds
    s_add_u32 m0, s65, 49664
    v_mul_f32 v56, s71, v56
    v_exp_f32 v56, v56
    s_waitcnt vmcnt(17)
    v_lshlrev_b32 v57, 16, v35
    v_mul_f32 v57, v57, v38
    v_cvt_pk_bf16_f32 v56, v56, v56
    v_mul_f32 v57, 0.15915494, v57
    v_lshlrev_b32 v56, 16, v56
    v_mul_f32 v56, v56, v38
    v_mul_f32 v56, s71, v56
    v_mul_f32 v59, 0x41000000, v57
    v_mul_f32 v58, 0x41000000, v56
    v_fract_f32 v59, v59
    v_exp_f32 v58, -v58
    v_cos_f32 v44, v59
    buffer_load_dwordx4 v8, s[40:43], s64 offen offset:0 lds
    v_sin_f32 v45, v59
    v_mul_f32 v44, v44, v58
    v_mul_f32 v45, v45, v58
    v_fract_f32 v59, v57
    v_exp_f32 v58, -v56
    v_cos_f32 v42, v59
    v_sin_f32 v43, v59
    v_mul_f32 v42, v42, v58
    v_mul_f32 v43, v43, v58
    v_mul_f32 v59, 0x43800000, v57
    v_mul_f32 v58, 0x43800000, v56
    v_fract_f32 v59, v59
    v_exp_f32 v58, -v58
    v_cos_f32 v46, v59
    buffer_load_dwordx4 v9, s[40:43], s64 offen offset:1024 lds
    v_sin_f32 v47, v59
    v_mul_f32 v46, v46, v58
    v_mul_f32 v47, v47, v58
    v_add_f32 v58, v38, v38
    s_waitcnt vmcnt(18)
    v_lshlrev_b32 v128, 16, v36
    s_waitcnt vmcnt(17)
    v_lshlrev_b32 v129, 16, v37
    v_mul_f32 v128, v128, v58
    v_mul_f32 v129, v129, v58
    v_mov_b32 v52, 0x3f80
    v_cvt_pk_bf16_f32 v54, v128, -v129
    v_cvt_pk_bf16_f32 v53, v44, v45
    v_pk_mul_f32 v[130:131], v[128:129], v[42:43] op_sel:[0,0] op_sel_hi:[1,0]
    ds_write2_b32 v40, v52, v53 offset0:0 offset1:4
    v_pk_mul_f32 v[48:49], v[44:45], v[44:45] op_sel:[0,0] op_sel_hi:[1,0]
    buffer_load_dwordx4 v10, s[40:43], s64 offen offset:2048 lds
    v_pk_fma_f32 v[130:131], v[128:129], v[42:43], v[130:131] op_sel:[1,1,0] op_sel_hi:[0,1,1] neg_lo:[1,0,0]
    v_pk_fma_f32 v[48:49], v[44:45], v[44:45], v[48:49] op_sel:[1,1,0] op_sel_hi:[0,1,1] neg_lo:[1,0,0]
    v_cvt_pk_bf16_f32 v55, v130, -v131
    v_cvt_pk_bf16_f32 v52, v48, v49
    v_pk_mul_f32 v[50:51], v[48:49], v[44:45] op_sel:[0,0] op_sel_hi:[1,0]
    ds_write2_b32 v40, v54, v55 offset0:128 offset1:132
    v_pk_fma_f32 v[50:51], v[48:49], v[44:45], v[50:51] op_sel:[1,1,0] op_sel_hi:[0,1,1] neg_lo:[1,0,0]
    v_pk_mul_f32 v[132:133], v[130:131], v[42:43] op_sel:[0,0] op_sel_hi:[1,0]
    v_cvt_pk_bf16_f32 v53, v50, v51
    ds_write2_b32 v40, v52, v53 offset0:8 offset1:12
    v_pk_fma_f32 v[132:133], v[130:131], v[42:43], v[132:133] op_sel:[1,1,0] op_sel_hi:[0,1,1] neg_lo:[1,0,0]
    v_pk_mul_f32 v[48:49], v[50:51], v[44:45] op_sel:[0,0] op_sel_hi:[1,0]
    v_cvt_pk_bf16_f32 v54, v132, -v133
    v_pk_fma_f32 v[48:49], v[50:51], v[44:45], v[48:49] op_sel:[1,1,0] op_sel_hi:[0,1,1] neg_lo:[1,0,0]
    buffer_load_dwordx4 v11, s[40:43], s64 offen offset:3072 lds
    s_add_u32 m0, s65, 66048
    s_add_u32 s63, s63, 128
    s_add_u32 s64, s64, 229376
    s_cmpk_eq_u32 s63, 896
    s_cselect_b32 s63, 0, s63
    s_cselect_b32 s64, 0, s64
    v_cvt_pk_bf16_f32 v52, v48, v49
    v_pk_mul_f32 v[134:135], v[132:133], v[42:43] op_sel:[0,0] op_sel_hi:[1,0]
    v_pk_mul_f32 v[50:51], v[48:49], v[44:45] op_sel:[0,0] op_sel_hi:[1,0]
    v_pk_fma_f32 v[134:135], v[132:133], v[42:43], v[134:135] op_sel:[1,1,0] op_sel_hi:[0,1,1] neg_lo:[1,0,0]
    v_pk_fma_f32 v[50:51], v[48:49], v[44:45], v[50:51] op_sel:[1,1,0] op_sel_hi:[0,1,1] neg_lo:[1,0,0]
    v_cvt_pk_bf16_f32 v53, v50, v51
    v_cvt_pk_bf16_f32 v55, v134, -v135
    ds_write2_b32 v40, v52, v53 offset0:16 offset1:20
    ds_write2_b32 v40, v54, v55 offset0:136 offset1:140
    v_pk_mul_f32 v[48:49], v[50:51], v[44:45] op_sel:[0,0] op_sel_hi:[1,0]
    v_pk_fma_f32 v[48:49], v[50:51], v[44:45], v[48:49] op_sel:[1,1,0] op_sel_hi:[0,1,1] neg_lo:[1,0,0]
    v_pk_mul_f32 v[136:137], v[134:135], v[42:43] op_sel:[0,0] op_sel_hi:[1,0]
    v_cvt_pk_bf16_f32 v52, v48, v49
    v_pk_fma_f32 v[136:137], v[134:135], v[42:43], v[136:137] op_sel:[1,1,0] op_sel_hi:[0,1,1] neg_lo:[1,0,0]
    buffer_load_dwordx4 v4, s[36:39], s63 offen offset:0 lds
    v_pk_mul_f32 v[50:51], v[48:49], v[44:45] op_sel:[0,0] op_sel_hi:[1,0]
    v_pk_fma_f32 v[50:51], v[48:49], v[44:45], v[50:51] op_sel:[1,1,0] op_sel_hi:[0,1,1] neg_lo:[1,0,0]
    v_cvt_pk_bf16_f32 v54, v136, -v137
    v_cvt_pk_bf16_f32 v53, v50, v51
    v_pk_mul_f32 v[138:139], v[136:137], v[42:43] op_sel:[0,0] op_sel_hi:[1,0]
    ds_write2_b32 v40, v52, v53 offset0:24 offset1:28
    v_pk_mul_f32 v[48:49], v[50:51], v[44:45] op_sel:[0,0] op_sel_hi:[1,0]
    v_pk_fma_f32 v[138:139], v[136:137], v[42:43], v[138:139] op_sel:[1,1,0] op_sel_hi:[0,1,1] neg_lo:[1,0,0]
    v_pk_fma_f32 v[48:49], v[50:51], v[44:45], v[48:49] op_sel:[1,1,0] op_sel_hi:[0,1,1] neg_lo:[1,0,0]
    v_cvt_pk_bf16_f32 v55, v138, -v139
    v_cvt_pk_bf16_f32 v52, v48, v49
    v_pk_mul_f32 v[50:51], v[48:49], v[44:45] op_sel:[0,0] op_sel_hi:[1,0]
    ds_write2_b32 v40, v54, v55 offset0:144 offset1:148
    v_pk_fma_f32 v[50:51], v[48:49], v[44:45], v[50:51] op_sel:[1,1,0] op_sel_hi:[0,1,1] neg_lo:[1,0,0]
    buffer_load_dwordx4 v5, s[36:39], s63 offen offset:1024 lds
    v_pk_mul_f32 v[140:141], v[138:139], v[42:43] op_sel:[0,0] op_sel_hi:[1,0]
    v_cvt_pk_bf16_f32 v53, v50, v51
    ds_write2_b32 v40, v52, v53 offset0:32 offset1:36
    v_pk_fma_f32 v[140:141], v[138:139], v[42:43], v[140:141] op_sel:[1,1,0] op_sel_hi:[0,1,1] neg_lo:[1,0,0]
    v_pk_mul_f32 v[48:49], v[50:51], v[44:45] op_sel:[0,0] op_sel_hi:[1,0]
    v_cvt_pk_bf16_f32 v54, v140, -v141
    s_lshl2_add_u32 s67, s2, s56
    s_mul_i32 s67, s67, 1792
    v_lshl_add_u32 v252, v1, 7, s67
    s_bfm_b64 exec, 14, 0
    global_load_dword v251, v252, s[24:25]
    s_mov_b64 exec, -1
    v_pk_fma_f32 v[48:49], v[50:51], v[44:45], v[48:49] op_sel:[1,1,0] op_sel_hi:[0,1,1] neg_lo:[1,0,0]
    v_cvt_pk_bf16_f32 v52, v48, v49
    v_pk_mul_f32 v[142:143], v[140:141], v[42:43] op_sel:[0,0] op_sel_hi:[1,0]
    v_pk_mul_f32 v[50:51], v[48:49], v[44:45] op_sel:[0,0] op_sel_hi:[1,0]
    v_pk_fma_f32 v[142:143], v[140:141], v[42:43], v[142:143] op_sel:[1,1,0] op_sel_hi:[0,1,1] neg_lo:[1,0,0]
    v_pk_fma_f32 v[50:51], v[48:49], v[44:45], v[50:51] op_sel:[1,1,0] op_sel_hi:[0,1,1] neg_lo:[1,0,0]
    v_cvt_pk_bf16_f32 v53, v50, v51
    v_cvt_pk_bf16_f32 v55, v142, -v143
    buffer_load_dwordx4 v6, s[36:39], s63 offen offset:2048 lds
    ds_write2_b32 v40, v52, v53 offset0:40 offset1:44
    ds_write2_b32 v40, v54, v55 offset0:152 offset1:156
    v_pk_mul_f32 v[48:49], v[50:51], v[44:45] op_sel:[0,0] op_sel_hi:[1,0]
    v_pk_fma_f32 v[48:49], v[50:51], v[44:45], v[48:49] op_sel:[1,1,0] op_sel_hi:[0,1,1] neg_lo:[1,0,0]
    v_pk_mul_f32 v[144:145], v[128:129], v[46:47] op_sel:[0,0] op_sel_hi:[1,0]
    v_cvt_pk_bf16_f32 v52, v48, v49
    v_pk_fma_f32 v[144:145], v[128:129], v[46:47], v[144:145] op_sel:[1,1,0] op_sel_hi:[0,1,1] neg_lo:[1,0,0]
    v_pk_mul_f32 v[50:51], v[48:49], v[44:45] op_sel:[0,0] op_sel_hi:[1,0]
    v_pk_fma_f32 v[50:51], v[48:49], v[44:45], v[50:51] op_sel:[1,1,0] op_sel_hi:[0,1,1] neg_lo:[1,0,0]
    v_cvt_pk_bf16_f32 v54, v144, -v145
    v_cvt_pk_bf16_f32 v53, v50, v51
    v_pk_mul_f32 v[146:147], v[132:133], v[46:47] op_sel:[0,0] op_sel_hi:[1,0]
    ds_write2_b32 v40, v52, v53 offset0:48 offset1:52
    v_pk_mul_f32 v[48:49], v[50:51], v[44:45] op_sel:[0,0] op_sel_hi:[1,0]
    buffer_load_dwordx4 v7, s[36:39], s63 offen offset:3072 lds
    s_add_u32 m0, s65, 82432
    v_pk_fma_f32 v[146:147], v[132:133], v[46:47], v[146:147] op_sel:[1,1,0] op_sel_hi:[0,1,1] neg_lo:[1,0,0]
    v_pk_fma_f32 v[48:49], v[50:51], v[44:45], v[48:49] op_sel:[1,1,0] op_sel_hi:[0,1,1] neg_lo:[1,0,0]
    v_cvt_pk_bf16_f32 v55, v146, -v147
    v_cvt_pk_bf16_f32 v52, v48, v49
    v_pk_mul_f32 v[50:51], v[48:49], v[44:45] op_sel:[0,0] op_sel_hi:[1,0]
    ds_write2_b32 v40, v54, v55 offset0:160 offset1:164
    v_pk_fma_f32 v[50:51], v[48:49], v[44:45], v[50:51] op_sel:[1,1,0] op_sel_hi:[0,1,1] neg_lo:[1,0,0]
    v_pk_mul_f32 v[148:149], v[136:137], v[46:47] op_sel:[0,0] op_sel_hi:[1,0]
    v_cvt_pk_bf16_f32 v53, v50, v51
    ds_write2_b32 v40, v52, v53 offset0:56 offset1:60
    v_pk_fma_f32 v[148:149], v[136:137], v[46:47], v[148:149] op_sel:[1,1,0] op_sel_hi:[0,1,1] neg_lo:[1,0,0]
    v_pk_mul_f32 v[48:49], v[50:51], v[44:45] op_sel:[0,0] op_sel_hi:[1,0]
    v_cvt_pk_bf16_f32 v54, v148, -v149
    v_pk_fma_f32 v[48:49], v[50:51], v[44:45], v[48:49] op_sel:[1,1,0] op_sel_hi:[0,1,1] neg_lo:[1,0,0]
    buffer_load_dwordx4 v8, s[40:43], s64 offen offset:0 lds
    v_cvt_pk_bf16_f32 v52, v48, v49
    v_pk_mul_f32 v[150:151], v[140:141], v[46:47] op_sel:[0,0] op_sel_hi:[1,0]
    v_pk_mul_f32 v[50:51], v[48:49], v[44:45] op_sel:[0,0] op_sel_hi:[1,0]
    v_pk_fma_f32 v[150:151], v[140:141], v[46:47], v[150:151] op_sel:[1,1,0] op_sel_hi:[0,1,1] neg_lo:[1,0,0]
    v_pk_fma_f32 v[50:51], v[48:49], v[44:45], v[50:51] op_sel:[1,1,0] op_sel_hi:[0,1,1] neg_lo:[1,0,0]
    v_cvt_pk_bf16_f32 v53, v50, v51
    v_cvt_pk_bf16_f32 v55, v150, -v151
    ds_write2_b32 v40, v52, v53 offset0:64 offset1:68
    ds_write2_b32 v40, v54, v55 offset0:168 offset1:172
    v_pk_mul_f32 v[48:49], v[50:51], v[44:45] op_sel:[0,0] op_sel_hi:[1,0]
    v_pk_fma_f32 v[48:49], v[50:51], v[44:45], v[48:49] op_sel:[1,1,0] op_sel_hi:[0,1,1] neg_lo:[1,0,0]
    v_pk_mul_f32 v[152:153], v[144:145], v[46:47] op_sel:[0,0] op_sel_hi:[1,0]
    v_cvt_pk_bf16_f32 v52, v48, v49
    v_pk_fma_f32 v[152:153], v[144:145], v[46:47], v[152:153] op_sel:[1,1,0] op_sel_hi:[0,1,1] neg_lo:[1,0,0]
    buffer_load_dwordx4 v9, s[40:43], s64 offen offset:1024 lds
    v_pk_mul_f32 v[50:51], v[48:49], v[44:45] op_sel:[0,0] op_sel_hi:[1,0]
    v_pk_fma_f32 v[50:51], v[48:49], v[44:45], v[50:51] op_sel:[1,1,0] op_sel_hi:[0,1,1] neg_lo:[1,0,0]
    v_cvt_pk_bf16_f32 v54, v152, -v153
    v_cvt_pk_bf16_f32 v53, v50, v51
    v_pk_mul_f32 v[154:155], v[148:149], v[46:47] op_sel:[0,0] op_sel_hi:[1,0]
    ds_write2_b32 v40, v52, v53 offset0:72 offset1:76
    v_pk_mul_f32 v[48:49], v[50:51], v[44:45] op_sel:[0,0] op_sel_hi:[1,0]
    v_pk_fma_f32 v[154:155], v[148:149], v[46:47], v[154:155] op_sel:[1,1,0] op_sel_hi:[0,1,1] neg_lo:[1,0,0]
    v_pk_fma_f32 v[48:49], v[50:51], v[44:45], v[48:49] op_sel:[1,1,0] op_sel_hi:[0,1,1] neg_lo:[1,0,0]
    v_cvt_pk_bf16_f32 v55, v154, -v155
    v_cvt_pk_bf16_f32 v52, v48, v49
    v_pk_mul_f32 v[50:51], v[48:49], v[44:45] op_sel:[0,0] op_sel_hi:[1,0]
    ds_write2_b32 v40, v54, v55 offset0:176 offset1:180
    v_pk_fma_f32 v[50:51], v[48:49], v[44:45], v[50:51] op_sel:[1,1,0] op_sel_hi:[0,1,1] neg_lo:[1,0,0]
    buffer_load_dwordx4 v10, s[40:43], s64 offen offset:2048 lds
    v_pk_mul_f32 v[156:157], v[152:153], v[46:47] op_sel:[0,0] op_sel_hi:[1,0]
    v_cvt_pk_bf16_f32 v53, v50, v51
    ds_write2_b32 v40, v52, v53 offset0:80 offset1:84
    v_pk_fma_f32 v[156:157], v[152:153], v[46:47], v[156:157] op_sel:[1,1,0] op_sel_hi:[0,1,1] neg_lo:[1,0,0]
    v_pk_mul_f32 v[48:49], v[50:51], v[44:45] op_sel:[0,0] op_sel_hi:[1,0]
    v_cvt_pk_bf16_f32 v54, v156, -v157
    v_pk_fma_f32 v[48:49], v[50:51], v[44:45], v[48:49] op_sel:[1,1,0] op_sel_hi:[0,1,1] neg_lo:[1,0,0]
    v_cvt_pk_bf16_f32 v52, v48, v49
    v_pk_mul_f32 v[158:159], v[154:155], v[46:47] op_sel:[0,0] op_sel_hi:[1,0]
    v_pk_mul_f32 v[50:51], v[48:49], v[44:45] op_sel:[0,0] op_sel_hi:[1,0]
    v_pk_fma_f32 v[158:159], v[154:155], v[46:47], v[158:159] op_sel:[1,1,0] op_sel_hi:[0,1,1] neg_lo:[1,0,0]
    v_pk_fma_f32 v[50:51], v[48:49], v[44:45], v[50:51] op_sel:[1,1,0] op_sel_hi:[0,1,1] neg_lo:[1,0,0]
    v_cvt_pk_bf16_f32 v53, v50, v51
    v_cvt_pk_bf16_f32 v55, v158, -v159
    buffer_load_dwordx4 v11, s[40:43], s64 offen offset:3072 lds
    s_add_u32 m0, s65, 512
    s_add_u32 s63, s63, 128
    s_add_u32 s64, s64, 229376
    s_cmpk_eq_u32 s63, 896
    s_cselect_b32 s63, 0, s63
    s_cselect_b32 s64, 0, s64
    ds_write2_b32 v40, v52, v53 offset0:88 offset1:92
    ds_write2_b32 v40, v54, v55 offset0:184 offset1:188
    v_pk_mul_f32 v[48:49], v[50:51], v[44:45] op_sel:[0,0] op_sel_hi:[1,0]
    v_pk_fma_f32 v[48:49], v[50:51], v[44:45], v[48:49] op_sel:[1,1,0] op_sel_hi:[0,1,1] neg_lo:[1,0,0]
    v_pk_mul_f32 v[160:161], v[156:157], v[46:47] op_sel:[0,0] op_sel_hi:[1,0]
    v_cvt_pk_bf16_f32 v52, v48, v49
    v_pk_fma_f32 v[160:161], v[156:157], v[46:47], v[160:161] op_sel:[1,1,0] op_sel_hi:[0,1,1] neg_lo:[1,0,0]
    v_pk_mul_f32 v[50:51], v[48:49], v[44:45] op_sel:[0,0] op_sel_hi:[1,0]
    v_pk_fma_f32 v[50:51], v[48:49], v[44:45], v[50:51] op_sel:[1,1,0] op_sel_hi:[0,1,1] neg_lo:[1,0,0]
    v_cvt_pk_bf16_f32 v54, v160, -v161
    v_cvt_pk_bf16_f32 v53, v50, v51
    v_pk_mul_f32 v[162:163], v[160:161], v[46:47] op_sel:[0,0] op_sel_hi:[1,0]
    ds_write2_b32 v40, v52, v53 offset0:96 offset1:100
    v_pk_mul_f32 v[48:49], v[50:51], v[44:45] op_sel:[0,0] op_sel_hi:[1,0]
    v_pk_fma_f32 v[162:163], v[160:161], v[46:47], v[162:163] op_sel:[1,1,0] op_sel_hi:[0,1,1] neg_lo:[1,0,0]
    v_pk_fma_f32 v[48:49], v[50:51], v[44:45], v[48:49] op_sel:[1,1,0] op_sel_hi:[0,1,1] neg_lo:[1,0,0]
    v_cvt_pk_bf16_f32 v55, v162, -v163
    v_cvt_pk_bf16_f32 v52, v48, v49
    v_pk_mul_f32 v[50:51], v[48:49], v[44:45] op_sel:[0,0] op_sel_hi:[1,0]
    ds_write2_b32 v40, v54, v55 offset0:192 offset1:196
    v_pk_fma_f32 v[50:51], v[48:49], v[44:45], v[50:51] op_sel:[1,1,0] op_sel_hi:[0,1,1] neg_lo:[1,0,0]
    v_pk_mul_f32 v[164:165], v[162:163], v[46:47] op_sel:[0,0] op_sel_hi:[1,0]
    v_cvt_pk_bf16_f32 v53, v50, v51
    ds_write2_b32 v40, v52, v53 offset0:104 offset1:108
    v_pk_fma_f32 v[164:165], v[162:163], v[46:47], v[164:165] op_sel:[1,1,0] op_sel_hi:[0,1,1] neg_lo:[1,0,0]
    v_pk_mul_f32 v[48:49], v[50:51], v[44:45] op_sel:[0,0] op_sel_hi:[1,0]
    v_cvt_pk_bf16_f32 v54, v164, -v165
    v_pk_fma_f32 v[48:49], v[50:51], v[44:45], v[48:49] op_sel:[1,1,0] op_sel_hi:[0,1,1] neg_lo:[1,0,0]
    v_cvt_pk_bf16_f32 v52, v48, v49
    v_pk_mul_f32 v[166:167], v[164:165], v[46:47] op_sel:[0,0] op_sel_hi:[1,0]
    v_pk_mul_f32 v[50:51], v[48:49], v[44:45] op_sel:[0,0] op_sel_hi:[1,0]
    v_pk_fma_f32 v[166:167], v[164:165], v[46:47], v[166:167] op_sel:[1,1,0] op_sel_hi:[0,1,1] neg_lo:[1,0,0]
    v_pk_fma_f32 v[50:51], v[48:49], v[44:45], v[50:51] op_sel:[1,1,0] op_sel_hi:[0,1,1] neg_lo:[1,0,0]
    v_cvt_pk_bf16_f32 v53, v50, v51
    v_cvt_pk_bf16_f32 v55, v166, -v167
    ds_write2_b32 v40, v52, v53 offset0:112 offset1:116
    ds_write2_b32 v40, v54, v55 offset0:200 offset1:204
    v_pk_mul_f32 v[48:49], v[50:51], v[44:45] op_sel:[0,0] op_sel_hi:[1,0]
    v_pk_fma_f32 v[48:49], v[50:51], v[44:45], v[48:49] op_sel:[1,1,0] op_sel_hi:[0,1,1] neg_lo:[1,0,0]
    v_pk_mul_f32 v[168:169], v[166:167], v[46:47] op_sel:[0,0] op_sel_hi:[1,0]
    v_cvt_pk_bf16_f32 v52, v48, v49
    v_pk_fma_f32 v[168:169], v[166:167], v[46:47], v[168:169] op_sel:[1,1,0] op_sel_hi:[0,1,1] neg_lo:[1,0,0]
    v_pk_mul_f32 v[50:51], v[48:49], v[44:45] op_sel:[0,0] op_sel_hi:[1,0]
    v_pk_fma_f32 v[50:51], v[48:49], v[44:45], v[50:51] op_sel:[1,1,0] op_sel_hi:[0,1,1] neg_lo:[1,0,0]
    v_cvt_pk_bf16_f32 v54, v168, -v169
    v_cvt_pk_bf16_f32 v53, v50, v51
    ds_write_b32 v40, v54 offset:832
    ds_write2_b32 v40, v52, v53 offset0:120 offset1:124
    ds_read_b128 a[160:163], v41 offset:0
    ds_read_b128 a[164:167], v41 offset:512
    ds_read_b128 a[168:171], v41 offset:1696
    ds_read_b128 a[172:175], v41 offset:2208
    ds_read_b128 a[176:179], v41 offset:3392
    ds_read_b128 a[180:183], v41 offset:3904
    s_waitcnt lgkmcnt(4)
    v_mfma_f32_32x32x16_bf16 a[224:239], a[160:163], a[164:167], 0
    ds_read_b128 a[184:187], v41 offset:5088
    ds_read_b128 a[188:191], v41 offset:5600
    v_and_b32 v56, 0xffff0000, v34
    v_mul_f32 v56, s71, v56
    v_exp_f32 v56, v56
    v_and_b32 v57, 0xffff0000, v35
    s_waitcnt lgkmcnt(4)
    v_mfma_f32_32x32x16_bf16 a[224:239], a[168:171], a[172:175], a[224:239]
    ds_read_b128 a[192:195], v41 offset:6784
    ds_read_b128 a[196:199], v41 offset:7296
    v_mul_f32 v57, v57, v38
    v_cvt_pk_bf16_f32 v56, v56, v56
    v_mul_f32 v57, 0.15915494, v57
    v_lshlrev_b32 v56, 16, v56
    s_waitcnt lgkmcnt(4)
    v_mfma_f32_32x32x16_bf16 a[224:239], a[176:179], a[180:183], a[224:239]
    ds_read_b128 a[200:203], v41 offset:8480
    ds_read_b128 a[204:207], v41 offset:8992
    v_mul_f32 v56, v56, v38
    v_mul_f32 v56, s71, v56
    v_mul_f32 v59, 0x41000000, v57
    v_mul_f32 v58, 0x41000000, v56
    s_waitcnt lgkmcnt(4)
    v_mfma_f32_32x32x16_bf16 a[224:239], a[184:187], a[188:191], a[224:239]
    ds_read_b128 a[208:211], v41 offset:10176
    ds_read_b128 a[212:215], v41 offset:10688
    v_fract_f32 v59, v59
    v_exp_f32 v58, -v58
    v_cos_f32 v44, v59
    v_sin_f32 v45, v59
    s_waitcnt lgkmcnt(4)
    v_mfma_f32_32x32x16_bf16 a[224:239], a[192:195], a[196:199], a[224:239]
    ds_read_b128 a[216:219], v41 offset:11872
    ds_read_b128 a[220:223], v41 offset:12384
    v_mul_f32 v44, v44, v58
    v_mul_f32 v45, v45, v58
    v_fract_f32 v59, v57
    v_exp_f32 v58, -v56
    s_waitcnt lgkmcnt(4)
    v_mfma_f32_32x32x16_bf16 a[224:239], a[200:203], a[204:207], a[224:239]
    v_cos_f32 v42, v59
    v_sin_f32 v43, v59
    v_mul_f32 v42, v42, v58
    v_mul_f32 v43, v43, v58
    v_mul_f32 v59, 0x43800000, v57
    v_mul_f32 v58, 0x43800000, v56
    s_waitcnt lgkmcnt(2)
    v_mfma_f32_32x32x16_bf16 a[224:239], a[208:211], a[212:215], a[224:239]
    v_fract_f32 v59, v59
    v_exp_f32 v58, -v58
    v_cos_f32 v46, v59
    v_sin_f32 v47, v59
    v_mul_f32 v46, v46, v58
    v_mul_f32 v47, v47, v58
    s_waitcnt lgkmcnt(0)
    v_mfma_f32_32x32x16_bf16 a[224:239], a[216:219], a[220:223], a[224:239]
    v_add_f32 v58, v38, v38
    v_and_b32 v128, 0xffff0000, v36
    v_and_b32 v129, 0xffff0000, v37
    v_mul_f32 v128, v128, v58
    v_mul_f32 v129, v129, v58
    s_waitcnt vmcnt(20)
    s_barrier
    ds_read_b64_tr_b16 a[96:97], v20 offset:0
    ds_read_b64_tr_b16 a[98:99], v20 offset:1024
    ds_read_b128 a[104:107], v12 offset:0
    s_waitcnt vmcnt(18)
    v_mfma_f32_32x32x16_bf16 v[64:79], v[24:27], v[30:33], 0
    ds_read_b128 a[108:111], v12 offset:4096
    ds_read_b64_tr_b16 a[100:101], v21 offset:0
    ds_read_b64_tr_b16 a[102:103], v21 offset:1024
    v_mfma_f32_32x32x16_bf16 v[80:95], v[24:27], v[30:33], 0
    buffer_load_dwordx4 a[0:3], v236, s[44:47], s11 offen offset:0
    v_mfma_f32_32x32x16_bf16 v[96:111], v[26:29], v[30:33], 0
    v_mfma_f32_32x32x16_bf16 v[112:127], v[26:29], v[30:33], 0
    buffer_load_dwordx4 a[4:7], v237, s[44:47], s11 offen offset:1024
    s_waitcnt lgkmcnt(3)
    v_mfma_f32_32x32x16_bf16 v[64:79], a[96:99], a[104:107], v[64:79]
    ds_read_b64_tr_b16 a[112:113], v20 offset:4096
    ds_read_b64_tr_b16 a[114:115], v20 offset:5120
    ds_read_b128 a[120:123], v13 offset:0
    s_mov_b32 s61, s60
    v_mov_b32 v24, v236
    v_mov_b32 v25, v237
    s_waitcnt lgkmcnt(5)
    v_mfma_f32_32x32x16_bf16 v[80:95], a[96:99], a[108:111], v[80:95]
    buffer_load_dwordx4 a[8:11], v238, s[44:47], s11 offen offset:2048
    v_mov_b32 v26, v238
    v_mov_b32 v27, v239
    v_and_b32 v2, 31, v1
    v_lshlrev_b32 v61, 2, v2
    v_lshlrev_b32 v60, 4, v1
    s_waitcnt lgkmcnt(3)
    v_mfma_f32_32x32x16_bf16 v[96:111], a[100:103], a[104:107], v[96:111]
    ds_read_b128 a[124:127], v13 offset:4096
    ds_read_b64_tr_b16 a[116:117], v21 offset:4096
    ds_read_b64_tr_b16 a[118:119], v21 offset:5120
    s_lshl_b32 s66, s56, 13
    s_mov_b64 s[48:49], s[34:35]
    s_mov_b32 s50, 20971520
    v_mfma_f32_32x32x16_bf16 v[112:127], a[100:103], a[108:111], v[112:127]
    buffer_load_dwordx4 a[12:15], v239, s[44:47], s11 offen offset:3072
    s_mov_b32 s51, 0x00020000
    s_mov_b64 s[52:53], s[30:31]
    s_mov_b32 s54, 1835008
    s_mov_b32 s55, 0x00020000
    v_lshrrev_b32 v2, 5, v1
    s_waitcnt lgkmcnt(3)
    v_mfma_f32_32x32x16_bf16 v[64:79], a[112:115], a[120:123], v[64:79]
    ds_read_b64_tr_b16 a[128:129], v20 offset:8192
    ds_read_b64_tr_b16 a[130:131], v20 offset:9216
    ds_read_b128 a[136:139], v14 offset:0
    v_bfe_u32 v3, v1, 2, 2
    v_lshl_add_u32 v2, v2, 2, v3
    v_lshlrev_b32 v2, 7, v2
    s_waitcnt lgkmcnt(5)
    v_mfma_f32_32x32x16_bf16 v[80:95], a[112:115], a[124:127], v[80:95]
    buffer_load_dwordx4 a[16:19], v236, s[44:47], s12 offen offset:0
    v_bfe_u32 v3, v1, 3, 1
    v_lshl_add_u32 v2, v3, 6, v2
    v_bfe_u32 v3, v1, 4, 1
    v_lshl_add_u32 v2, v3, 5, v2
    v_and_b32 v3, 3, v1
    s_waitcnt lgkmcnt(3)
    v_mfma_f32_32x32x16_bf16 v[96:111], a[116:119], a[120:123], v[96:111]
    ds_read_b128 a[140:143], v14 offset:4096
    ds_read_b64_tr_b16 a[132:133], v21 offset:8192
    ds_read_b64_tr_b16 a[134:135], v21 offset:9216
    v_lshl_add_u32 v2, v3, 3, v2
    s_add_u32 s67, s66, 33280
    v_add_u32 v28, s67, v2
    v_mfma_f32_32x32x16_bf16 v[112:127], a[116:119], a[124:127], v[112:127]
    buffer_load_dwordx4 a[20:23], v237, s[44:47], s12 offen offset:1024
    v_xor_b32 v29, 64, v28
    s_and_b32 s67, s56, 1
    s_lshl1_add_u32 s67, s57, s67
    s_mul_i32 s67, s67, 224
    s_lshl3_add_u32 s67, s58, s67
    s_waitcnt lgkmcnt(3)
    v_mfma_f32_32x32x16_bf16 v[64:79], a[128:131], a[136:139], v[64:79]
    ds_read_b64_tr_b16 a[144:145], v20 offset:12288
    ds_read_b64_tr_b16 a[146:147], v20 offset:13312
    ds_read_b128 a[152:155], v15 offset:0
    s_and_b32 s68, s56, 2
    s_lshl1_add_u32 s67, s68, s67
    s_lshl_b32 s67, s67, 10
    s_waitcnt lgkmcnt(5)
    v_mfma_f32_32x32x16_bf16 v[80:95], a[128:131], a[140:143], v[80:95]
    ds_read_b128 a[156:159], v15 offset:4096
    ds_read_b64_tr_b16 a[148:149], v21 offset:12288
    ds_read_b64_tr_b16 a[150:151], v21 offset:13312
    s_add_u32 s19, s67, 4194304
    s_add_u32 s3, s19, 114688
    s_mul_i32 s68, s56, 28
    s_waitcnt lgkmcnt(6)
    v_mfma_f32_32x32x16_bf16 v[96:111], a[132:135], a[136:139], v[96:111]
    buffer_load_dwordx4 a[24:27], v238, s[44:47], s12 offen offset:2048
    s_lshl_b32 s67, s59, 7
    s_add_u32 s67, s67, s68
    s_lshl_b32 s67, s67, 5
    s_add_u32 s15, s67, 14680064
    s_mul_i32 s67, s59, 224
    v_mfma_f32_32x32x16_bf16 v[112:127], a[132:135], a[140:143], v[112:127]
    buffer_load_dwordx4 a[28:31], v239, s[44:47], s12 offen offset:3072
    s_add_u32 s67, s67, s68
    s_lshl_b32 s67, s67, 10
    s_add_u32 s67, s67, 4194304
    s_add_u32 s68, s67, 28672
    s_lshl_b32 s4, s61, 12
    s_waitcnt lgkmcnt(3)
    v_mfma_f32_32x32x16_bf16 v[64:79], a[144:147], a[152:155], v[64:79]
    s_waitcnt vmcnt(17) lgkmcnt(0)
    s_barrier
    ds_read_b64_tr_b16 a[96:97], v20 offset:32768
    ds_read_b64_tr_b16 a[98:99], v20 offset:33792
    ds_read_b128 a[104:107], v12 offset:32768
    s_add_u32 s4, s4, s67
    s_add_u32 s5, s4, 4096
    v_mfma_f32_32x32x16_bf16 v[80:95], a[144:147], a[156:159], v[80:95]
    buffer_load_dwordx4 v4, s[36:39], s63 offen offset:0 lds
    s_cmp_eq_u32 s5, s68
    s_cselect_b32 s5, s67, s5
    s_add_u32 s6, s5, 4096
    s_cmp_eq_u32 s6, s68
    s_cselect_b32 s6, s67, s6
    v_mfma_f32_32x32x16_bf16 v[96:111], a[148:151], a[152:155], v[96:111]
    ds_read_b128 a[108:111], v12 offset:36864
    ds_read_b64_tr_b16 a[100:101], v21 offset:32768
    ds_read_b64_tr_b16 a[102:103], v21 offset:33792
    s_add_u32 s7, s6, 4096
    s_cmp_eq_u32 s7, s68
    s_cselect_b32 s7, s67, s7
    v_mfma_f32_32x32x16_bf16 v[112:127], a[148:151], a[156:159], v[112:127]
    buffer_load_dwordx4 v5, s[36:39], s63 offen offset:1024 lds
    s_add_u32 s8, s7, 4096
    s_cmp_eq_u32 s8, s68
    s_cselect_b32 s8, s67, s8
    s_add_u32 s9, s8, 4096
    s_waitcnt lgkmcnt(3)
    v_mfma_f32_32x32x16_bf16 v[64:79], a[96:99], a[104:107], v[64:79]
    ds_read_b64_tr_b16 a[112:113], v20 offset:36864
    ds_read_b64_tr_b16 a[114:115], v20 offset:37888
    ds_read_b128 a[120:123], v13 offset:32768
    s_cmp_eq_u32 s9, s68
    s_cselect_b32 s9, s67, s9
    s_add_u32 s10, s9, 4096
    s_waitcnt lgkmcnt(5)
    v_mfma_f32_32x32x16_bf16 v[80:95], a[96:99], a[108:111], v[80:95]
    buffer_load_dwordx4 v6, s[36:39], s63 offen offset:2048 lds
    s_cmp_eq_u32 s10, s68
    s_cselect_b32 s10, s67, s10
    v_and_b32 v2, 127, v0
    v_cmp_eq_u32 vcc, 0, v2
    v_lshlrev_b32 v39, 16, v39
    s_waitcnt lgkmcnt(3)
    v_mfma_f32_32x32x16_bf16 v[96:111], a[100:103], a[104:107], v[96:111]
    ds_read_b128 a[124:127], v13 offset:36864
    ds_read_b64_tr_b16 a[116:117], v21 offset:36864
    ds_read_b64_tr_b16 a[118:119], v21 offset:37888
    v_accvgpr_read_b32 v3, a224
    v_cndmask_b32 v39, 0, v39, vcc
    v_add_f32 v3, v3, v39
    v_mfma_f32_32x32x16_bf16 v[112:127], a[100:103], a[108:111], v[112:127]
    buffer_load_dwordx4 v7, s[36:39], s63 offen offset:3072 lds
    s_add_u32 m0, s65, 16896
    v_accvgpr_write_b32 a224, v3
    v_mov_b32 v180, 0x3f80
    v_cvt_pk_bf16_f32 v181, v128, -v129
    v_cvt_pk_bf16_f32 v182, v44, v45
    v_mul_f32 v130, v128, v42
    s_waitcnt lgkmcnt(3)
    v_mfma_f32_32x32x16_bf16 v[64:79], a[112:115], a[120:123], v[64:79]
    ds_read_b64_tr_b16 a[128:129], v20 offset:40960
    ds_read_b64_tr_b16 a[130:131], v20 offset:41984
    ds_read_b128 a[136:139], v14 offset:32768
    v_mul_f32 v131, v129, v42
    v_mul_f32 v48, v44, v44
    v_mul_f32 v49, v45, v44
    s_waitcnt lgkmcnt(5)
    v_mfma_f32_32x32x16_bf16 v[80:95], a[112:115], a[124:127], v[80:95]
    buffer_load_dwordx4 v8, s[40:43], s64 offen offset:0 lds
    v_fma_f32 v130, -v129, v43, v130
    v_fmac_f32 v131, v128, v43
    v_fma_f32 v48, -v45, v45, v48
    v_fmac_f32 v49, v44, v45
    v_cvt_pk_bf16_f32 v183, v130, -v131
    s_waitcnt lgkmcnt(3)
    v_mfma_f32_32x32x16_bf16 v[96:111], a[116:119], a[120:123], v[96:111]
    ds_read_b128 a[140:143], v14 offset:36864
    ds_read_b64_tr_b16 a[132:133], v21 offset:40960
    ds_read_b64_tr_b16 a[134:135], v21 offset:41984
    v_cvt_pk_bf16_f32 v184, v48, v49
    v_mul_f32 v50, v48, v44
    v_mul_f32 v51, v49, v44
    v_mfma_f32_32x32x16_bf16 v[112:127], a[116:119], a[124:127], v[112:127]
    buffer_load_dwordx4 v9, s[40:43], s64 offen offset:1024 lds
    v_fma_f32 v50, -v49, v45, v50
    v_fmac_f32 v51, v48, v45
    v_mul_f32 v132, v130, v42
    v_mul_f32 v133, v131, v42
    v_cvt_pk_bf16_f32 v185, v50, v51
    s_waitcnt lgkmcnt(3)
    v_mfma_f32_32x32x16_bf16 v[64:79], a[128:131], a[136:139], v[64:79]
    ds_read_b64_tr_b16 a[144:145], v20 offset:45056
    ds_read_b64_tr_b16 a[146:147], v20 offset:46080
    ds_read_b128 a[152:155], v15 offset:32768
    v_fma_f32 v132, -v131, v43, v132
    v_fmac_f32 v133, v130, v43
    v_mul_f32 v48, v50, v44
    s_waitcnt lgkmcnt(5)
    v_mfma_f32_32x32x16_bf16 v[80:95], a[128:131], a[140:143], v[80:95]
    ds_read_b128 a[156:159], v15 offset:36864
    ds_read_b64_tr_b16 a[148:149], v21 offset:45056
    ds_read_b64_tr_b16 a[150:151], v21 offset:46080
    v_mul_f32 v49, v51, v44
    v_cvt_pk_bf16_f32 v186, v132, -v133
    v_fma_f32 v48, -v51, v45, v48
    s_waitcnt lgkmcnt(6)
    v_mfma_f32_32x32x16_bf16 v[96:111], a[132:135], a[136:139], v[96:111]
    buffer_load_dwordx4 v10, s[40:43], s64 offen offset:2048 lds
    v_fmac_f32 v49, v50, v45
    v_cvt_pk_bf16_f32 v187, v48, v49
    v_mul_f32 v134, v132, v42
    v_mul_f32 v135, v133, v42
    v_mul_f32 v50, v48, v44
    v_mfma_f32_32x32x16_bf16 v[112:127], a[132:135], a[140:143], v[112:127]
    buffer_load_dwordx4 v11, s[40:43], s64 offen offset:3072 lds
    s_add_u32 m0, s65, 33280
    s_add_u32 s63, s63, 128
    s_add_u32 s64, s64, 229376
    s_cmpk_eq_u32 s63, 896
    s_cselect_b32 s63, 0, s63
    s_cselect_b32 s64, 0, s64
    v_mul_f32 v51, v49, v44
    v_fma_f32 v134, -v133, v43, v134
    v_fmac_f32 v135, v132, v43
    v_fma_f32 v50, -v49, v45, v50
    v_fmac_f32 v51, v48, v45
    s_waitcnt lgkmcnt(3)
    v_mfma_f32_32x32x16_bf16 v[64:79], a[144:147], a[152:155], v[64:79]
    s_waitcnt vmcnt(16) lgkmcnt(0)
    s_barrier
    ds_read_b64_tr_b16 a[96:97], v22 offset:0
    ds_read_b64_tr_b16 a[98:99], v22 offset:1024
    ds_read_b128 a[104:107], v16 offset:0
    v_cvt_pk_bf16_f32 v188, v50, v51
    v_cvt_pk_bf16_f32 v189, v134, -v135
    v_mul_f32 v48, v50, v44
    v_mfma_f32_32x32x16_bf16 v[80:95], a[144:147], a[156:159], v[80:95]
    buffer_load_dwordx4 v4, s[36:39], s63 offen offset:0 lds
    v_mul_f32 v49, v51, v44
    v_fma_f32 v48, -v51, v45, v48
    v_fmac_f32 v49, v50, v45
    v_mul_f32 v136, v134, v42
    v_mul_f32 v137, v135, v42
    v_mfma_f32_32x32x16_bf16 v[96:111], a[148:151], a[152:155], v[96:111]
    ds_read_b128 a[108:111], v16 offset:4096
    ds_read_b64_tr_b16 a[100:101], v23 offset:0
    ds_read_b64_tr_b16 a[102:103], v23 offset:1024
    v_cvt_pk_bf16_f32 v190, v48, v49
    v_fma_f32 v136, -v135, v43, v136
    v_fmac_f32 v137, v134, v43
    v_mfma_f32_32x32x16_bf16 v[112:127], a[148:151], a[156:159], v[112:127]
    buffer_load_dwordx4 v5, s[36:39], s63 offen offset:1024 lds
    v_mul_f32 v50, v48, v44
    v_mul_f32 v51, v49, v44
    v_fma_f32 v50, -v49, v45, v50
    v_fmac_f32 v51, v48, v45
    v_cvt_pk_bf16_f32 v191, v136, -v137
    s_waitcnt lgkmcnt(3)
    v_mfma_f32_32x32x16_bf16 v[64:79], a[96:99], a[104:107], v[64:79]
    ds_read_b64_tr_b16 a[112:113], v22 offset:4096
    ds_read_b64_tr_b16 a[114:115], v22 offset:5120
    ds_read_b128 a[120:123], v17 offset:0
    v_cvt_pk_bf16_f32 v192, v50, v51
    v_mul_f32 v138, v136, v42
    v_mul_f32 v139, v137, v42
    s_waitcnt lgkmcnt(5)
    v_mfma_f32_32x32x16_bf16 v[80:95], a[96:99], a[108:111], v[80:95]
    buffer_load_dwordx4 v6, s[36:39], s63 offen offset:2048 lds
    v_mul_f32 v48, v50, v44
    v_mul_f32 v49, v51, v44
    v_fma_f32 v138, -v137, v43, v138
    v_fmac_f32 v139, v136, v43
    v_fma_f32 v48, -v51, v45, v48
    s_waitcnt lgkmcnt(3)
    v_mfma_f32_32x32x16_bf16 v[96:111], a[100:103], a[104:107], v[96:111]
    ds_read_b128 a[124:127], v17 offset:4096
    ds_read_b64_tr_b16 a[116:117], v23 offset:4096
    ds_read_b64_tr_b16 a[118:119], v23 offset:5120
    v_fmac_f32 v49, v50, v45
    v_cvt_pk_bf16_f32 v193, v138, -v139
    v_cvt_pk_bf16_f32 v194, v48, v49
    v_mfma_f32_32x32x16_bf16 v[112:127], a[100:103], a[108:111], v[112:127]
    buffer_load_dwordx4 v7, s[36:39], s63 offen offset:3072 lds
    s_add_u32 m0, s65, 49664
    v_mul_f32 v50, v48, v44
    v_mul_f32 v51, v49, v44
    v_fma_f32 v50, -v49, v45, v50
    v_fmac_f32 v51, v48, v45
    v_mul_f32 v140, v138, v42
    s_waitcnt lgkmcnt(3)
    v_mfma_f32_32x32x16_bf16 v[64:79], a[112:115], a[120:123], v[64:79]
    ds_read_b64_tr_b16 a[128:129], v22 offset:8192
    ds_read_b64_tr_b16 a[130:131], v22 offset:9216
    ds_read_b128 a[136:139], v18 offset:0
    v_mul_f32 v141, v139, v42
    v_cvt_pk_bf16_f32 v195, v50, v51
    v_fma_f32 v140, -v139, v43, v140
    s_waitcnt lgkmcnt(5)
    v_mfma_f32_32x32x16_bf16 v[80:95], a[112:115], a[124:127], v[80:95]
    buffer_load_dwordx4 v8, s[40:43], s64 offen offset:0 lds
    v_fmac_f32 v141, v138, v43
    v_mul_f32 v48, v50, v44
    v_mul_f32 v49, v51, v44
    v_cvt_pk_bf16_f32 v196, v140, -v141
    v_fma_f32 v48, -v51, v45, v48
    s_waitcnt lgkmcnt(3)
    v_mfma_f32_32x32x16_bf16 v[96:111], a[116:119], a[120:123], v[96:111]
    ds_read_b128 a[140:143], v18 offset:4096
    ds_read_b64_tr_b16 a[132:133], v23 offset:8192
    ds_read_b64_tr_b16 a[134:135], v23 offset:9216
    v_fmac_f32 v49, v50, v45
    v_cvt_pk_bf16_f32 v197, v48, v49
    v_mul_f32 v142, v140, v42
    v_mfma_f32_32x32x16_bf16 v[112:127], a[116:119], a[124:127], v[112:127]
    buffer_load_dwordx4 v9, s[40:43], s64 offen offset:1024 lds
    v_mul_f32 v143, v141, v42
    v_mul_f32 v50, v48, v44
    v_mul_f32 v51, v49, v44
    v_fma_f32 v142, -v141, v43, v142
    v_fmac_f32 v143, v140, v43
    s_waitcnt lgkmcnt(3)
    v_mfma_f32_32x32x16_bf16 v[64:79], a[128:131], a[136:139], v[64:79]
    ds_read_b64_tr_b16 a[144:145], v22 offset:12288
    ds_read_b64_tr_b16 a[146:147], v22 offset:13312
    ds_read_b128 a[152:155], v19 offset:0
    v_fma_f32 v50, -v49, v45, v50
    v_fmac_f32 v51, v48, v45
    v_cvt_pk_bf16_f32 v198, v50, v51
    s_waitcnt lgkmcnt(5)
    v_mfma_f32_32x32x16_bf16 v[80:95], a[128:131], a[140:143], v[80:95]
    ds_read_b128 a[156:159], v19 offset:4096
    ds_read_b64_tr_b16 a[148:149], v23 offset:12288
    ds_read_b64_tr_b16 a[150:151], v23 offset:13312
    v_cvt_pk_bf16_f32 v199, v142, -v143
    v_mul_f32 v48, v50, v44
    v_mul_f32 v49, v51, v44
    s_waitcnt lgkmcnt(6)
    v_mfma_f32_32x32x16_bf16 v[96:111], a[132:135], a[136:139], v[96:111]
    buffer_load_dwordx4 v10, s[40:43], s64 offen offset:2048 lds
    v_fma_f32 v48, -v51, v45, v48
    v_fmac_f32 v49, v50, v45
    v_mul_f32 v144, v128, v46
    v_mul_f32 v145, v129, v46
    v_cvt_pk_bf16_f32 v200, v48, v49
    v_mfma_f32_32x32x16_bf16 v[112:127], a[132:135], a[140:143], v[112:127]
    buffer_load_dwordx4 v11, s[40:43], s64 offen offset:3072 lds
    s_add_u32 m0, s65, 66048
    s_add_u32 s63, s63, 128
    s_add_u32 s64, s64, 229376
    s_cmpk_eq_u32 s63, 896
    s_cselect_b32 s63, 0, s63
    s_cselect_b32 s64, 0, s64
    v_fma_f32 v144, -v129, v47, v144
    v_fmac_f32 v145, v128, v47
    v_mul_f32 v50, v48, v44
    v_mul_f32 v51, v49, v44
    v_fma_f32 v50, -v49, v45, v50
    s_waitcnt lgkmcnt(3)
    v_mfma_f32_32x32x16_bf16 v[64:79], a[144:147], a[152:155], v[64:79]
    s_waitcnt vmcnt(8) lgkmcnt(0)
    s_barrier
    ds_read_b64_tr_b16 a[96:97], v20 offset:0
    ds_read_b64_tr_b16 a[98:99], v20 offset:1024
    ds_read_b128 a[104:107], v12 offset:0
    v_fmac_f32 v51, v48, v45
    v_cvt_pk_bf16_f32 v201, v144, -v145
    v_cvt_pk_bf16_f32 v202, v50, v51
    v_mfma_f32_32x32x16_bf16 v[80:95], a[144:147], a[156:159], v[80:95]
    buffer_load_dwordx4 v4, s[36:39], s63 offen offset:0 lds
    v_mul_f32 v146, v132, v46
    v_mul_f32 v147, v133, v46
    v_mul_f32 v48, v50, v44
    v_mul_f32 v49, v51, v44
    v_fma_f32 v146, -v133, v47, v146
    v_mfma_f32_32x32x16_bf16 v[96:111], a[148:151], a[152:155], v[96:111]
    ds_read_b128 a[108:111], v12 offset:4096
    ds_read_b64_tr_b16 a[100:101], v21 offset:0
    ds_read_b64_tr_b16 a[102:103], v21 offset:1024
    v_fmac_f32 v147, v132, v47
    v_fma_f32 v48, -v51, v45, v48
    v_fmac_f32 v49, v50, v45
    v_mfma_f32_32x32x16_bf16 v[112:127], a[148:151], a[156:159], v[112:127]
    buffer_load_dwordx4 v5, s[36:39], s63 offen offset:1024 lds
    v_cvt_pk_bf16_f32 v203, v146, -v147
    v_cvt_pk_bf16_f32 v204, v48, v49
    v_mul_f32 v50, v48, v44
    v_mul_f32 v51, v49, v44
    v_fma_f32 v50, -v49, v45, v50
    s_waitcnt lgkmcnt(3)
    v_mfma_f32_32x32x16_bf16 v[64:79], a[96:99], a[104:107], v[64:79]
    ds_read_b64_tr_b16 a[112:113], v20 offset:4096
    ds_read_b64_tr_b16 a[114:115], v20 offset:5120
    ds_read_b128 a[120:123], v13 offset:0
    v_fmac_f32 v51, v48, v45
    v_mul_f32 v148, v136, v46
    v_mul_f32 v149, v137, v46
    s_waitcnt lgkmcnt(5)
    v_mfma_f32_32x32x16_bf16 v[80:95], a[96:99], a[108:111], v[80:95]
    buffer_load_dwordx4 v6, s[36:39], s63 offen offset:2048 lds
    v_cvt_pk_bf16_f32 v205, v50, v51
    v_fma_f32 v148, -v137, v47, v148
    v_fmac_f32 v149, v136, v47
    v_mul_f32 v48, v50, v44
    v_mul_f32 v49, v51, v44
    s_waitcnt lgkmcnt(3)
    v_mfma_f32_32x32x16_bf16 v[96:111], a[100:103], a[104:107], v[96:111]
    ds_read_b128 a[124:127], v13 offset:4096
    ds_read_b64_tr_b16 a[116:117], v21 offset:4096
    ds_read_b64_tr_b16 a[118:119], v21 offset:5120
    v_cvt_pk_bf16_f32 v206, v148, -v149
    v_fma_f32 v48, -v51, v45, v48
    v_fmac_f32 v49, v50, v45
    v_mfma_f32_32x32x16_bf16 v[112:127], a[100:103], a[108:111], v[112:127]
    buffer_load_dwordx4 v7, s[36:39], s63 offen offset:3072 lds
    s_add_u32 m0, s65, 82432
    v_cvt_pk_bf16_f32 v207, v48, v49
    v_mul_f32 v150, v140, v46
    v_mul_f32 v151, v141, v46
    v_mul_f32 v50, v48, v44
    v_mul_f32 v51, v49, v44
    s_waitcnt lgkmcnt(3)
    v_mfma_f32_32x32x16_bf16 v[64:79], a[112:115], a[120:123], v[64:79]
    ds_read_b64_tr_b16 a[128:129], v20 offset:8192
    ds_read_b64_tr_b16 a[130:131], v20 offset:9216
    ds_read_b128 a[136:139], v14 offset:0
    v_fma_f32 v150, -v141, v47, v150
    v_fmac_f32 v151, v140, v47
    v_fma_f32 v50, -v49, v45, v50
    s_waitcnt lgkmcnt(5)
    v_mfma_f32_32x32x16_bf16 v[80:95], a[112:115], a[124:127], v[80:95]
    buffer_load_dwordx4 v8, s[40:43], s64 offen offset:0 lds
    v_fmac_f32 v51, v48, v45
    v_cvt_pk_bf16_f32 v208, v50, v51
    v_cvt_pk_bf16_f32 v209, v150, -v151
    v_mul_f32 v48, v50, v44
    v_mul_f32 v49, v51, v44
    s_waitcnt lgkmcnt(3)
    v_mfma_f32_32x32x16_bf16 v[96:111], a[116:119], a[120:123], v[96:111]
    ds_read_b128 a[140:143], v14 offset:4096
    ds_read_b64_tr_b16 a[132:133], v21 offset:8192
    ds_read_b64_tr_b16 a[134:135], v21 offset:9216
    v_fma_f32 v48, -v51, v45, v48
    v_fmac_f32 v49, v50, v45
    v_mul_f32 v152, v144, v46
    v_mfma_f32_32x32x16_bf16 v[112:127], a[116:119], a[124:127], v[112:127]
    buffer_load_dwordx4 v9, s[40:43], s64 offen offset:1024 lds
    v_mul_f32 v153, v145, v46
    v_cvt_pk_bf16_f32 v210, v48, v49
    v_fma_f32 v152, -v145, v47, v152
    v_fmac_f32 v153, v144, v47
    v_mul_f32 v50, v48, v44
    s_waitcnt lgkmcnt(3)
    v_mfma_f32_32x32x16_bf16 v[64:79], a[128:131], a[136:139], v[64:79]
    ds_read_b64_tr_b16 a[144:145], v20 offset:12288
    ds_read_b64_tr_b16 a[146:147], v20 offset:13312
    ds_read_b128 a[152:155], v15 offset:0
    v_mul_f32 v51, v49, v44
    v_fma_f32 v50, -v49, v45, v50
    v_fmac_f32 v51, v48, v45
    s_waitcnt lgkmcnt(5)
    v_mfma_f32_32x32x16_bf16 v[80:95], a[128:131], a[140:143], v[80:95]
    ds_read_b128 a[156:159], v15 offset:4096
    ds_read_b64_tr_b16 a[148:149], v21 offset:12288
    ds_read_b64_tr_b16 a[150:151], v21 offset:13312
    v_cvt_pk_bf16_f32 v211, v152, -v153
    v_cvt_pk_bf16_f32 v212, v50, v51
    v_mul_f32 v154, v148, v46
    s_waitcnt lgkmcnt(6)
    v_mfma_f32_32x32x16_bf16 v[96:111], a[132:135], a[136:139], v[96:111]
    buffer_load_dwordx4 v10, s[40:43], s64 offen offset:2048 lds
    v_mul_f32 v155, v149, v46
    v_mul_f32 v48, v50, v44
    v_mul_f32 v49, v51, v44
    v_fma_f32 v154, -v149, v47, v154
    v_fmac_f32 v155, v148, v47
    v_mfma_f32_32x32x16_bf16 v[112:127], a[132:135], a[140:143], v[112:127]
    buffer_load_dwordx4 v11, s[40:43], s64 offen offset:3072 lds
    s_add_u32 m0, s65, 512
    s_add_u32 s63, s63, 128
    s_add_u32 s64, s64, 229376
    s_cmpk_eq_u32 s63, 896
    s_cselect_b32 s63, 0, s63
    s_cselect_b32 s64, 0, s64
    v_fma_f32 v48, -v51, v45, v48
    v_fmac_f32 v49, v50, v45
    v_cvt_pk_bf16_f32 v213, v154, -v155
    v_cvt_pk_bf16_f32 v214, v48, v49
    v_mul_f32 v50, v48, v44
    s_waitcnt lgkmcnt(3)
    v_mfma_f32_32x32x16_bf16 v[64:79], a[144:147], a[152:155], v[64:79]
    s_waitcnt vmcnt(8) lgkmcnt(0)
    s_barrier
    ds_read_b64_tr_b16 a[96:97], v20 offset:32768
    ds_read_b64_tr_b16 a[98:99], v20 offset:33792
    ds_read_b128 a[104:107], v12 offset:32768
    v_mul_f32 v51, v49, v44
    v_fma_f32 v50, -v49, v45, v50
    v_fmac_f32 v51, v48, v45
    v_mfma_f32_32x32x16_bf16 v[80:95], a[144:147], a[156:159], v[80:95]
    buffer_load_dwordx4 v4, s[36:39], s63 offen offset:0 lds
    v_mul_f32 v156, v152, v46
    v_mul_f32 v157, v153, v46
    v_cvt_pk_bf16_f32 v215, v50, v51
    v_fma_f32 v156, -v153, v47, v156
    v_fmac_f32 v157, v152, v47
    v_mfma_f32_32x32x16_bf16 v[96:111], a[148:151], a[152:155], v[96:111]
    ds_read_b128 a[108:111], v12 offset:36864
    ds_read_b64_tr_b16 a[100:101], v21 offset:32768
    ds_read_b64_tr_b16 a[102:103], v21 offset:33792
    v_mul_f32 v48, v50, v44
    v_mul_f32 v49, v51, v44
    v_cvt_pk_bf16_f32 v216, v156, -v157
    v_mfma_f32_32x32x16_bf16 v[112:127], a[148:151], a[156:159], v[112:127]
    buffer_load_dwordx4 v5, s[36:39], s63 offen offset:1024 lds
    v_fma_f32 v48, -v51, v45, v48
    v_fmac_f32 v49, v50, v45
    v_cvt_pk_bf16_f32 v217, v48, v49
    v_mul_f32 v158, v154, v46
    v_mul_f32 v159, v155, v46
    s_waitcnt lgkmcnt(3)
    v_mfma_f32_32x32x16_bf16 v[64:79], a[96:99], a[104:107], v[64:79]
    ds_read_b64_tr_b16 a[112:113], v20 offset:36864
    ds_read_b64_tr_b16 a[114:115], v20 offset:37888
    ds_read_b128 a[120:123], v13 offset:32768
    v_mul_f32 v50, v48, v44
    v_mul_f32 v51, v49, v44
    v_fma_f32 v158, -v155, v47, v158
    s_waitcnt lgkmcnt(5)
    v_mfma_f32_32x32x16_bf16 v[80:95], a[96:99], a[108:111], v[80:95]
    buffer_load_dwordx4 v6, s[36:39], s63 offen offset:2048 lds
    v_fmac_f32 v159, v154, v47
    v_fma_f32 v50, -v49, v45, v50
    v_fmac_f32 v51, v48, v45
    v_cvt_pk_bf16_f32 v218, v50, v51
    v_cvt_pk_bf16_f32 v219, v158, -v159
    s_waitcnt lgkmcnt(3)
    v_mfma_f32_32x32x16_bf16 v[96:111], a[100:103], a[104:107], v[96:111]
    ds_read_b128 a[124:127], v13 offset:36864
    ds_read_b64_tr_b16 a[116:117], v21 offset:36864
    ds_read_b64_tr_b16 a[118:119], v21 offset:37888
    v_mul_f32 v48, v50, v44
    v_mul_f32 v49, v51, v44
    v_fma_f32 v48, -v51, v45, v48
    v_mfma_f32_32x32x16_bf16 v[112:127], a[100:103], a[108:111], v[112:127]
    buffer_load_dwordx4 v7, s[36:39], s63 offen offset:3072 lds
    s_add_u32 m0, s65, 16896
    v_fmac_f32 v49, v50, v45
    v_mul_f32 v160, v156, v46
    v_mul_f32 v161, v157, v46
    v_cvt_pk_bf16_f32 v220, v48, v49
    v_fma_f32 v160, -v157, v47, v160
    s_waitcnt lgkmcnt(3)
    v_mfma_f32_32x32x16_bf16 v[64:79], a[112:115], a[120:123], v[64:79]
    ds_read_b64_tr_b16 a[128:129], v20 offset:40960
    ds_read_b64_tr_b16 a[130:131], v20 offset:41984
    ds_read_b128 a[136:139], v14 offset:32768
    v_fmac_f32 v161, v156, v47
    v_mul_f32 v50, v48, v44
    v_mul_f32 v51, v49, v44
    s_waitcnt lgkmcnt(5)
    v_mfma_f32_32x32x16_bf16 v[80:95], a[112:115], a[124:127], v[80:95]
    buffer_load_dwordx4 v8, s[40:43], s64 offen offset:0 lds
    v_fma_f32 v50, -v49, v45, v50
    v_fmac_f32 v51, v48, v45
    v_cvt_pk_bf16_f32 v221, v160, -v161
    v_cvt_pk_bf16_f32 v222, v50, v51
    v_mul_f32 v162, v160, v46
    s_waitcnt lgkmcnt(3)
    v_mfma_f32_32x32x16_bf16 v[96:111], a[116:119], a[120:123], v[96:111]
    ds_read_b128 a[140:143], v14 offset:36864
    ds_read_b64_tr_b16 a[132:133], v21 offset:40960
    ds_read_b64_tr_b16 a[134:135], v21 offset:41984
    v_mul_f32 v163, v161, v46
    v_mul_f32 v48, v50, v44
    v_mul_f32 v49, v51, v44
    v_mfma_f32_32x32x16_bf16 v[112:127], a[116:119], a[124:127], v[112:127]
    buffer_load_dwordx4 v9, s[40:43], s64 offen offset:1024 lds
    v_fma_f32 v162, -v161, v47, v162
    v_fmac_f32 v163, v160, v47
    v_fma_f32 v48, -v51, v45, v48
    v_fmac_f32 v49, v50, v45
    v_cvt_pk_bf16_f32 v223, v162, -v163
    s_waitcnt lgkmcnt(3)
    v_mfma_f32_32x32x16_bf16 v[64:79], a[128:131], a[136:139], v[64:79]
    ds_read_b64_tr_b16 a[144:145], v20 offset:45056
    ds_read_b64_tr_b16 a[146:147], v20 offset:46080
    ds_read_b128 a[152:155], v15 offset:32768
    v_cvt_pk_bf16_f32 v224, v48, v49
    v_mul_f32 v50, v48, v44
    v_mul_f32 v51, v49, v44
    s_waitcnt lgkmcnt(5)
    v_mfma_f32_32x32x16_bf16 v[80:95], a[128:131], a[140:143], v[80:95]
    ds_read_b128 a[156:159], v15 offset:36864
    ds_read_b64_tr_b16 a[148:149], v21 offset:45056
    ds_read_b64_tr_b16 a[150:151], v21 offset:46080
    v_fma_f32 v50, -v49, v45, v50
    v_fmac_f32 v51, v48, v45
    v_mul_f32 v164, v162, v46
    s_waitcnt lgkmcnt(6)
    v_mfma_f32_32x32x16_bf16 v[96:111], a[132:135], a[136:139], v[96:111]
    buffer_load_dwordx4 v10, s[40:43], s64 offen offset:2048 lds
    v_mul_f32 v165, v163, v46
    v_cvt_pk_bf16_f32 v225, v50, v51
    v_fma_f32 v164, -v163, v47, v164
    v_fmac_f32 v165, v162, v47
    v_mul_f32 v48, v50, v44
    v_mfma_f32_32x32x16_bf16 v[112:127], a[132:135], a[140:143], v[112:127]
    buffer_load_dwordx4 v11, s[40:43], s64 offen offset:3072 lds
    s_add_u32 m0, s66, 33280
    s_mul_i32 s64, s61, 57344
    v_mul_f32 v49, v51, v44
    v_cvt_pk_bf16_f32 v226, v164, -v165
    v_fma_f32 v48, -v51, v45, v48
    v_fmac_f32 v49, v50, v45
    v_cvt_pk_bf16_f32 v227, v48, v49
    s_waitcnt lgkmcnt(3)
    v_mfma_f32_32x32x16_bf16 v[64:79], a[144:147], a[152:155], v[64:79]
    s_waitcnt vmcnt(8) lgkmcnt(0)
    s_barrier
    ds_read_b64_tr_b16 a[96:97], v22 offset:0
    ds_read_b64_tr_b16 a[98:99], v22 offset:1024
    ds_read_b128 a[104:107], v16 offset:0
    v_mul_f32 v166, v164, v46
    v_mul_f32 v167, v165, v46
    v_mul_f32 v50, v48, v44
    s_lshr_b32 s16, s56, 1
    s_lshl_b32 s16, s16, 5
    s_add_u32 s16, s16, s62
    s_mul_i32 s16, s16, 4224
    s_and_b32 s17, s56, 1
    s_lshl2_add_u32 s16, s17, s16
    v_mfma_f32_32x32x16_bf16 v[80:95], a[144:147], a[156:159], v[80:95]
    s_add_u32 s70, s18, s64
    buffer_load_dwordx4 v24, s[44:47], s70 offen offset:0 lds
    v_mul_f32 v51, v49, v44
    v_fma_f32 v166, -v165, v47, v166
    v_fmac_f32 v167, v164, v47
    v_fma_f32 v50, -v49, v45, v50
    v_fmac_f32 v51, v48, v45
    s_lshl_b32 s17, s17, 11
    v_lshl_add_u32 v252, v1, 7, s17
    s_mul_i32 s17, s56, 8320
    v_mfma_f32_32x32x16_bf16 v[96:111], a[148:151], a[152:155], v[96:111]
    ds_read_b128 a[108:111], v16 offset:4096
    ds_read_b64_tr_b16 a[100:101], v23 offset:0
    ds_read_b64_tr_b16 a[102:103], v23 offset:1024
    s_mov_b64 exec, 0x1ffff
    buffer_load_dword v251, v252, s[48:51], s16 offen sc1
    s_mov_b64 exec, -1
    v_cvt_pk_bf16_f32 v228, v50, v51
    v_cvt_pk_bf16_f32 v229, v166, -v167
    v_mul_f32 v48, v50, v44
    v_mfma_f32_32x32x16_bf16 v[112:127], a[148:151], a[156:159], v[112:127]
    buffer_load_dwordx4 v25, s[44:47], s70 offen offset:1024 lds
    v_mul_f32 v49, v51, v44
    v_fma_f32 v48, -v51, v45, v48
    v_fmac_f32 v49, v50, v45
    v_mul_f32 v168, v166, v46
    v_mul_f32 v169, v167, v46
    s_waitcnt lgkmcnt(3)
    v_mfma_f32_32x32x16_bf16 v[64:79], a[96:99], a[104:107], v[64:79]
    ds_read_b64_tr_b16 a[112:113], v22 offset:4096
    ds_read_b64_tr_b16 a[114:115], v22 offset:5120
    ds_read_b128 a[120:123], v17 offset:0
    v_cvt_pk_bf16_f32 v230, v48, v49
    v_fma_f32 v168, -v167, v47, v168
    v_fmac_f32 v169, v166, v47
    s_waitcnt lgkmcnt(5)
    v_mfma_f32_32x32x16_bf16 v[80:95], a[96:99], a[108:111], v[80:95]
    buffer_load_dwordx4 v26, s[44:47], s70 offen offset:2048 lds
    v_mul_f32 v50, v48, v44
    v_mul_f32 v51, v49, v44
    v_fma_f32 v50, -v49, v45, v50
    v_fmac_f32 v51, v48, v45
    v_cvt_pk_bf16_f32 v231, v168, -v169
    s_waitcnt lgkmcnt(3)
    v_mfma_f32_32x32x16_bf16 v[96:111], a[100:103], a[104:107], v[96:111]
    ds_read_b128 a[124:127], v17 offset:4096
    ds_read_b64_tr_b16 a[116:117], v23 offset:4096
    ds_read_b64_tr_b16 a[118:119], v23 offset:5120
    v_cvt_pk_bf16_f32 v232, v50, v51
    v_mfma_f32_32x32x16_bf16 v[112:127], a[100:103], a[108:111], v[112:127]
    buffer_load_dwordx4 v27, s[44:47], s70 offen offset:3072 lds
    s_add_u32 m0, s66, 37376
    s_add_u32 s64, s64, 28672
    v_mov_b32 v240, 0
    v_mov_b32 v241, 0
    v_mov_b32 v242, 0
    v_mov_b32 v243, 0
    v_lshrrev_b32 v244, 3, v1
    s_waitcnt lgkmcnt(3)
    v_mfma_f32_32x32x16_bf16 v[64:79], a[112:115], a[120:123], v[64:79]
    ds_read_b64_tr_b16 a[128:129], v22 offset:8192
    ds_read_b64_tr_b16 a[130:131], v22 offset:9216
    ds_read_b128 a[136:139], v18 offset:0
    v_mul_u32_u24 v244, 4160, v244
    v_and_b32 v3, 7, v1
    v_lshl_add_u32 v244, v3, 3, v244
    s_waitcnt lgkmcnt(5)
    v_mfma_f32_32x32x16_bf16 v[80:95], a[112:115], a[124:127], v[80:95]
    s_add_u32 s70, s18, s64
    buffer_load_dwordx4 v24, s[44:47], s70 offen offset:0 lds
    v_lshrrev_b32 v245, 5, v1
    v_mul_u32_u24 v245, 4096, v245
    v_add_u32 v245, v245, v60
    v_add_u32 v245, 157184, v245
    v_and_b32 v2, 3, v1
    s_waitcnt lgkmcnt(3)
    v_mfma_f32_32x32x16_bf16 v[96:111], a[116:119], a[120:123], v[96:111]
    ds_read_b128 a[140:143], v18 offset:4096
    ds_read_b64_tr_b16 a[132:133], v23 offset:8192
    ds_read_b64_tr_b16 a[134:135], v23 offset:9216
    v_mul_u32_u24 v7, 320, v2
    v_mul_u32_u24 v2, 4160, v2
    v_and_b32 v3, 12, v1
    v_mfma_f32_32x32x16_bf16 v[112:127], a[116:119], a[124:127], v[112:127]
    buffer_load_dwordx4 v25, s[44:47], s70 offen offset:1024 lds
    v_lshl_add_u32 v2, v3, 1, v2
    v_lshrrev_b32 v3, 4, v1
    v_lshl_add_u32 v2, v3, 4, v2
    s_lshr_b32 s67, s56, 1
    s_and_b32 s68, s56, 1
    s_waitcnt lgkmcnt(3)
    v_mfma_f32_32x32x16_bf16 v[64:79], a[128:131], a[136:139], v[64:79]
    ds_read_b64_tr_b16 a[144:145], v22 offset:12288
    ds_read_b64_tr_b16 a[146:147], v22 offset:13312
    ds_read_b128 a[152:155], v19 offset:0
    s_lshl_b32 s68, s68, 8
    s_mul_i32 s69, s67, 16640
    s_add_u32 s69, s69, s68
    s_waitcnt lgkmcnt(5)
    v_mfma_f32_32x32x16_bf16 v[80:95], a[128:131], a[140:143], v[80:95]
    ds_read_b128 a[156:159], v19 offset:4096
    ds_read_b64_tr_b16 a[148:149], v23 offset:12288
    ds_read_b64_tr_b16 a[150:151], v23 offset:13312
    s_add_u32 s69, s69, 40
    v_add_u32 v4, s69, v2
    s_mul_i32 s69, s67, 4608
    s_waitcnt lgkmcnt(6)
    v_mfma_f32_32x32x16_bf16 v[96:111], a[132:135], a[136:139], v[96:111]
    buffer_load_dwordx4 v26, s[44:47], s70 offen offset:2048 lds
    s_add_u32 s69, s69, s68
    s_add_u32 s69, s69, 153568
    v_and_b32 v2, 15, v1
    v_mul_u32_u24 v6, 320, v3
    v_lshl_add_u32 v6, v2, 4, v6
    v_mfma_f32_32x32x16_bf16 v[112:127], a[132:135], a[140:143], v[112:127]
    buffer_load_dwordx4 v27, s[44:47], s70 offen offset:3072 lds
    s_add_u32 m0, s66, 66048
    s_add_u32 s64, s64, 28672
    s_cmp_eq_u32 s64, 401408
    s_cselect_b32 s64, 0, s64
    v_lshlrev_b32 v2, 5, v2
    v_lshlrev_b32 v3, 4, v3
    v_sub_u32 v2, v3, v2
    v_add_u32 v5, s69, v2
    s_mul_i32 s69, s56, 10240
    s_waitcnt lgkmcnt(3)
    v_mfma_f32_32x32x16_bf16 v[64:79], a[144:147], a[152:155], v[64:79]
    s_waitcnt vmcnt(9) lgkmcnt(0)
    s_barrier
    ds_read_b64_tr_b16 a[32:33], v20 offset:0
    ds_read_b64_tr_b16 a[34:35], v20 offset:1024
    ds_read_b128 a[40:43], v12 offset:0
    s_add_u32 s69, s69, 98816
    v_add_u32 v6, s69, v6
    v_lshrrev_b32 v2, 2, v1
    v_mfma_f32_32x32x16_bf16 v[80:95], a[144:147], a[156:159], v[80:95]
    ds_read_b64_tr_b16 a[48:49], v20 offset:4096
    ds_read_b64_tr_b16 a[50:51], v20 offset:5120
    ds_read_b128 a[56:59], v13 offset:0
    v_lshl_add_u32 v7, v2, 4, v7
    s_mul_i32 s69, s56, 2560
    s_add_u32 s69, s69, 98816
    v_mfma_f32_32x32x16_bf16 v[96:111], a[148:151], a[152:155], v[96:111]
    ds_read_b64_tr_b16 a[64:65], v20 offset:8192
    ds_read_b64_tr_b16 a[66:67], v20 offset:9216
    ds_read_b128 a[72:75], v14 offset:0
    v_add_u32 v7, s69, v7
    v_lshlrev_b32 v9, 4, v0
    v_add_u32 v9, 153088, v9
    v_mfma_f32_32x32x16_bf16 v[112:127], a[148:151], a[156:159], v[112:127]
    ds_read_b64_tr_b16 a[80:81], v20 offset:12288
    ds_read_b64_tr_b16 a[82:83], v20 offset:13312
    ds_read_b128 a[88:91], v15 offset:0
    s_lshl_b32 s69, s56, 7
    v_xor_b32 v22, s69, v60
    v_add_u32 v23, 114688, v22
    s_waitcnt lgkmcnt(9)
    v_mfma_f32_32x32x16_bf16 v[64:79], a[32:35], a[40:43], v[64:79]
    ds_read_b128 a[44:47], v12 offset:4096
    ds_read_b128 a[60:63], v13 offset:4096
    s_add_u32 s70, s18, s64
    buffer_load_dwordx4 v24, s[44:47], s70 offen offset:0 lds
    v_add_u32 v30, s66, v60
    s_waitcnt lgkmcnt(8)
    v_mfma_f32_32x32x16_bf16 v[64:79], a[48:51], a[56:59], v[64:79]
    ds_read_b128 a[76:79], v14 offset:4096
    ds_read_b128 a[92:95], v15 offset:4096
    buffer_load_dwordx4 v25, s[44:47], s70 offen offset:1024 lds
    s_waitcnt lgkmcnt(7)
    v_mfma_f32_32x32x16_bf16 v[64:79], a[64:67], a[72:75], v[64:79]
    ds_read_b64_tr_b16 a[36:37], v21 offset:0
    ds_read_b64_tr_b16 a[38:39], v21 offset:1024
    s_waitcnt lgkmcnt(6)
    v_mfma_f32_32x32x16_bf16 v[64:79], a[80:83], a[88:91], v[64:79]
    ds_read_b64_tr_b16 a[52:53], v21 offset:4096
    ds_read_b64_tr_b16 a[54:55], v21 offset:5120
    buffer_load_dwordx4 v26, s[44:47], s70 offen offset:2048 lds
    s_waitcnt lgkmcnt(7)
    v_mfma_f32_32x32x16_bf16 v[80:95], a[32:35], a[44:47], v[80:95]
    ds_read_b64_tr_b16 a[68:69], v21 offset:8192
    ds_read_b64_tr_b16 a[70:71], v21 offset:9216
    global_load_dword v250, v61, s[32:33] sc1
    s_waitcnt lgkmcnt(8)
    v_mfma_f32_32x32x16_bf16 v[80:95], a[48:51], a[60:63], v[80:95]
    ds_read_b64_tr_b16 a[84:85], v21 offset:12288
    ds_read_b64_tr_b16 a[86:87], v21 offset:13312
    buffer_load_dwordx4 v27, s[44:47], s70 offen offset:3072 lds
    s_add_u32 m0, s66, 70144
    s_add_u32 s64, s64, 28672
    v_mul_f32 v64, v64, |v64|
    v_mul_f32 v65, v65, |v65|
    v_mul_f32 v66, v66, |v66|
    v_mul_f32 v67, v67, |v67|
    v_mul_f32 v68, v68, |v68|
    s_waitcnt lgkmcnt(9)
    v_mfma_f32_32x32x16_bf16 v[80:95], a[64:67], a[76:79], v[80:95]
    s_add_u32 s70, s18, s64
    buffer_load_dwordx4 v24, s[44:47], s70 offen offset:0 lds
    v_mul_f32 v69, v69, |v69|
    v_mul_f32 v70, v70, |v70|
    v_mul_f32 v71, v71, |v71|
    v_cvt_pk_bf16_f32 v64, v64, v65
    v_cvt_pk_bf16_f32 v65, v66, v67
    s_waitcnt lgkmcnt(8)
    v_mfma_f32_32x32x16_bf16 v[80:95], a[80:83], a[92:95], v[80:95]
    buffer_load_dwordx4 v25, s[44:47], s70 offen offset:1024 lds
    v_cvt_pk_bf16_f32 v66, v68, v69
    v_cvt_pk_bf16_f32 v67, v70, v71
    v_pk_max_i16 v64, v64, 0
    v_pk_max_i16 v65, v65, 0
    v_pk_max_i16 v66, v66, 0
    s_waitcnt lgkmcnt(6)
    v_mfma_f32_32x32x16_bf16 v[96:111], a[36:39], a[40:43], v[96:111]
    s_waitcnt lgkmcnt(0)
    s_barrier
    v_pk_max_i16 v67, v67, 0
    v_mul_f32 v72, v72, |v72|
    v_mul_f32 v73, v73, |v73|
    v_mul_f32 v74, v74, |v74|
    v_mul_f32 v75, v75, |v75|
    v_mul_f32 v76, v76, |v76|
    v_mfma_f32_32x32x16_bf16 v[96:111], a[52:55], a[56:59], v[96:111]
    buffer_load_dwordx4 v26, s[44:47], s70 offen offset:2048 lds
    v_mul_f32 v77, v77, |v77|
    v_mul_f32 v78, v78, |v78|
    v_mul_f32 v79, v79, |v79|
    v_cvt_pk_bf16_f32 v72, v72, v73
    v_cvt_pk_bf16_f32 v73, v74, v75
    v_mfma_f32_32x32x16_bf16 v[96:111], a[68:71], a[72:75], v[96:111]
    v_cvt_pk_bf16_f32 v74, v76, v77
    v_cvt_pk_bf16_f32 v75, v78, v79
    v_pk_max_i16 v72, v72, 0
    v_pk_max_i16 v73, v73, 0
    v_pk_max_i16 v74, v74, 0
    v_pk_max_i16 v75, v75, 0
    v_mfma_f32_32x32x16_bf16 v[96:111], a[84:87], a[88:91], v[96:111]
    buffer_load_dwordx4 v27, s[44:47], s70 offen offset:3072 lds
    s_add_u32 m0, s17, 64
    s_add_u32 s64, s64, 28672
    s_cmp_eq_u32 s64, 401408
    s_cselect_b32 s64, 0, s64
    v_mul_f32 v80, v80, |v80|
    v_mul_f32 v81, v81, |v81|
    v_mul_f32 v82, v82, |v82|
    v_mul_f32 v83, v83, |v83|
    v_mul_f32 v84, v84, |v84|
    v_mfma_f32_32x32x16_bf16 v[112:127], a[36:39], a[44:47], v[112:127]
    v_mul_f32 v85, v85, |v85|
    v_mul_f32 v86, v86, |v86|
    v_mul_f32 v87, v87, |v87|
    v_cvt_pk_bf16_f32 v80, v80, v81
    v_cvt_pk_bf16_f32 v81, v82, v83
    v_cvt_pk_bf16_f32 v82, v84, v85
    v_mfma_f32_32x32x16_bf16 v[112:127], a[52:55], a[60:63], v[112:127]
    buffer_store_dwordx4 v[64:67], v60, s[48:51], s19 offen offset:0 sc1
    v_cvt_pk_bf16_f32 v83, v86, v87
    v_pk_max_i16 v80, v80, 0
    v_pk_max_i16 v81, v81, 0
    v_pk_max_i16 v82, v82, 0
    v_pk_max_i16 v83, v83, 0
    v_mfma_f32_32x32x16_bf16 v[112:127], a[68:71], a[76:79], v[112:127]
    buffer_store_dwordx4 v[72:75], v60, s[48:51], s19 offen offset:1024 sc1
    v_mul_f32 v88, v88, |v88|
    v_mul_f32 v89, v89, |v89|
    v_mul_f32 v90, v90, |v90|
    v_mul_f32 v91, v91, |v91|
    v_mul_f32 v92, v92, |v92|
    v_mfma_f32_32x32x16_bf16 v[112:127], a[84:87], a[92:95], v[112:127]
    buffer_store_dwordx4 v[80:83], v60, s[48:51], s3 offen offset:0 sc1
    v_mul_f32 v93, v93, |v93|
    v_mul_f32 v94, v94, |v94|
    v_mul_f32 v95, v95, |v95|
    v_cvt_pk_bf16_f32 v88, v88, v89
    v_cvt_pk_bf16_f32 v89, v90, v91
    ds_write2_b32 v40, v180, v182 offset0:0 offset1:4
    v_cvt_pk_bf16_f32 v90, v92, v93
    v_cvt_pk_bf16_f32 v91, v94, v95
    ds_write2_b32 v40, v181, v183 offset0:128 offset1:132
    s_waitcnt vmcnt(8)
    v_cmp_eq_u32 vcc, 0, v250
    s_cbranch_vccnz L_pu_s
L_pu_b:
    s_add_u32 s16, s16, 122
    buffer_load_dwordx4 v60, s[48:51], s16 offen offset:0 sc1 lds
    s_add_u32 m0, s66, 33280
    v_pk_max_i16 v88, v88, 0
    ds_write2_b32 v40, v184, v185 offset0:8 offset1:12
    v_pk_max_i16 v89, v89, 0
    v_pk_max_i16 v90, v90, 0
    ds_write2_b32 v40, v187, v188 offset0:16 offset1:20
    v_pk_max_i16 v91, v91, 0
    ds_write2_b32 v40, v186, v189 offset0:136 offset1:140
    buffer_store_dwordx4 v[88:91], v60, s[48:51], s3 offen offset:1024 sc1
    v_mul_f32 v96, v96, |v96|
    ds_read_b64_tr_b16 a[128:129], v28 offset:0
    ds_read_b64_tr_b16 a[130:131], v28 offset:1024
    ds_read_b64_tr_b16 a[132:133], v29 offset:0
    ds_write2_b32 v40, v190, v192 offset0:24 offset1:28
    v_mul_f32 v97, v97, |v97|
    ds_read_b64_tr_b16 a[134:135], v29 offset:1024
    ds_read_b64_tr_b16 a[136:137], v28 offset:2048
    ds_read_b64_tr_b16 a[138:139], v28 offset:3072
    ds_write2_b32 v40, v191, v193 offset0:144 offset1:148
    v_mul_f32 v98, v98, |v98|
    ds_read_b64_tr_b16 a[140:141], v29 offset:2048
    ds_read_b64_tr_b16 a[142:143], v29 offset:3072
    v_mul_f32 v99, v99, |v99|
    ds_write2_b32 v40, v194, v195 offset0:32 offset1:36
    v_mul_f32 v100, v100, |v100|
    ds_write2_b32 v40, v197, v198 offset0:40 offset1:44
    v_mul_f32 v101, v101, |v101|
    v_mul_f32 v102, v102, |v102|
    ds_write2_b32 v40, v196, v199 offset0:152 offset1:156
    v_mul_f32 v103, v103, |v103|
    ds_write2_b32 v40, v200, v202 offset0:48 offset1:52
    s_waitcnt lgkmcnt(4)
    s_add_u32 s70, s18, s64
    buffer_load_dwordx4 v24, s[44:47], s70 offen offset:0 lds
    s_add_u32 m0, s17, 64
    v_cvt_pk_bf16_f32 v96, v96, v97
    v_cvt_pk_bf16_f32 v97, v98, v99
    ds_write2_b32 v40, v201, v203 offset0:160 offset1:164
    v_cvt_pk_bf16_f32 v98, v100, v101
    ds_write2_b32 v40, v204, v205 offset0:56 offset1:60
    v_cvt_pk_bf16_f32 v99, v102, v103
    v_pk_max_i16 v96, v96, 0
    ds_write2_b32 v40, v207, v208 offset0:64 offset1:68
    v_pk_max_i16 v97, v97, 0
    buffer_load_dwordx4 v60, s[48:51], s16 offen offset:1024 sc1 lds
    s_add_u32 m0, s66, 33280
    ds_write2_b32 v40, v206, v209 offset0:168 offset1:172
    v_pk_max_i16 v98, v98, 0
    v_pk_max_i16 v99, v99, 0
    ds_write2_b32 v40, v210, v212 offset0:72 offset1:76
    buffer_store_dwordx4 v[96:99], v60, s[48:51], s19 offen offset:2048 sc1
    ds_write2_b32 v40, v211, v213 offset0:176 offset1:180
    v_mul_f32 v104, v104, |v104|
    v_mul_f32 v105, v105, |v105|
    ds_write2_b32 v40, v214, v215 offset0:80 offset1:84
    buffer_load_dwordx4 v25, s[44:47], s70 offen offset:1024 lds
    v_mul_f32 v106, v106, |v106|
    ds_write2_b32 v40, v217, v218 offset0:88 offset1:92
    v_mul_f32 v107, v107, |v107|
    v_mul_f32 v108, v108, |v108|
    ds_write2_b32 v40, v216, v219 offset0:184 offset1:188
    ds_read_b64_tr_b16 a[144:145], v28 offset:4096
    ds_read_b64_tr_b16 a[146:147], v28 offset:5120
    ds_read_b64_tr_b16 a[148:149], v29 offset:4096
    v_mul_f32 v109, v109, |v109|
    ds_write2_b32 v40, v220, v222 offset0:96 offset1:100
    v_mul_f32 v110, v110, |v110|
    v_mul_f32 v111, v111, |v111|
    buffer_load_dwordx4 v26, s[44:47], s70 offen offset:2048 lds
    s_add_u32 m0, s17, 64
    ds_write2_b32 v40, v221, v223 offset0:192 offset1:196
    v_cvt_pk_bf16_f32 v104, v104, v105
    ds_write2_b32 v40, v224, v225 offset0:104 offset1:108
    v_cvt_pk_bf16_f32 v105, v106, v107
    v_cvt_pk_bf16_f32 v106, v108, v109
    ds_write2_b32 v40, v227, v228 offset0:112 offset1:116
    v_cvt_pk_bf16_f32 v107, v110, v111
    ds_write2_b32 v40, v226, v229 offset0:200 offset1:204
    v_pk_max_i16 v104, v104, 0
    buffer_load_dwordx4 v60, s[48:51], s16 offen offset:2048 sc1 lds
    s_add_u32 m0, s66, 33280
    v_pk_max_i16 v105, v105, 0
    ds_write_b32 v40, v231 offset:832
    v_pk_max_i16 v106, v106, 0
    ds_write2_b32 v40, v230, v232 offset0:120 offset1:124
    v_pk_max_i16 v107, v107, 0
    ds_read_b64_tr_b16 a[150:151], v29 offset:5120
    ds_read_b64_tr_b16 a[152:153], v28 offset:6144
    ds_read_b64_tr_b16 a[154:155], v28 offset:7168
    ds_read_b128 a[160:163], v41 offset:0
    ds_read_b128 a[164:167], v41 offset:512
    ds_read_b128 a[168:171], v41 offset:1696
    ds_read_b128 a[172:175], v41 offset:2208
    buffer_load_dwordx4 v27, s[44:47], s70 offen offset:3072 lds
    s_add_u32 m0, s17, 64
    s_add_u32 s64, s64, 28672
    ds_read_b128 a[176:179], v41 offset:3392
    ds_read_b128 a[180:183], v41 offset:3904
    s_waitcnt lgkmcnt(4)
    v_mfma_f32_32x32x16_bf16 a[224:239], a[160:163], a[164:167], a[224:239]
    ds_read_b128 a[184:187], v41 offset:5088
    ds_read_b128 a[188:191], v41 offset:5600
    ds_read_b64_tr_b16 a[156:157], v29 offset:6144
    ds_read_b64_tr_b16 a[158:159], v29 offset:7168
    buffer_store_dwordx4 v[104:107], v60, s[48:51], s19 offen offset:3072 sc1
    v_mul_f32 v112, v112, |v112|
    v_mul_f32 v113, v113, |v113|
    v_mul_f32 v114, v114, |v114|
    buffer_load_dwordx4 v60, s[48:51], s16 offen offset:3072 sc1 lds
    s_add_u32 m0, s66, 37376
    v_mul_f32 v115, v115, |v115|
    s_waitcnt lgkmcnt(6)
    v_mfma_f32_32x32x16_bf16 a[224:239], a[168:171], a[172:175], a[224:239]
    ds_read_b128 a[192:195], v41 offset:6784
    ds_read_b128 a[196:199], v41 offset:7296
    v_mul_f32 v116, v116, |v116|
    v_mul_f32 v117, v117, |v117|
    v_mul_f32 v118, v118, |v118|
    v_mul_f32 v119, v119, |v119|
    s_waitcnt lgkmcnt(6)
    v_mfma_f32_32x32x16_bf16 a[224:239], a[176:179], a[180:183], a[224:239]
    s_waitcnt lgkmcnt(2)
    s_add_u32 s70, s18, s64
    buffer_load_dwordx4 v24, s[44:47], s70 offen offset:0 lds
    s_add_u32 m0, s17, 4224
    ds_read_b128 a[200:203], v41 offset:8480
    ds_read_b128 a[204:207], v41 offset:8992
    v_cvt_pk_bf16_f32 v112, v112, v113
    v_cvt_pk_bf16_f32 v113, v114, v115
    v_cvt_pk_bf16_f32 v114, v116, v117
    s_add_u32 s16, s16, 2
    buffer_load_dwordx4 v60, s[48:51], s16 offen offset:0 sc1 lds
    s_add_u32 m0, s66, 37376
    v_cvt_pk_bf16_f32 v115, v118, v119
    v_mfma_f32_32x32x16_bf16 a[224:239], a[184:187], a[188:191], a[224:239]
    ds_read_b128 a[208:211], v41 offset:10176
    ds_read_b128 a[212:215], v41 offset:10688
    v_pk_max_i16 v112, v112, 0
    v_pk_max_i16 v113, v113, 0
    v_pk_max_i16 v114, v114, 0
    v_pk_max_i16 v115, v115, 0
    s_waitcnt lgkmcnt(4)
    v_mfma_f32_32x32x16_bf16 a[224:239], a[192:195], a[196:199], a[224:239]
    buffer_load_dwordx4 v25, s[44:47], s70 offen offset:1024 lds
    s_add_u32 m0, s17, 4224
    ds_read_b128 a[216:219], v41 offset:11872
    ds_read_b128 a[220:223], v41 offset:12384
    buffer_store_dwordx4 v[112:115], v60, s[48:51], s3 offen offset:2048 sc1
    v_mul_f32 v120, v120, |v120|
    v_mul_f32 v121, v121, |v121|
    s_waitcnt vmcnt(22)
    ds_read_b64_tr_b16 a[32:33], v28 offset:32768
    ds_read_b64_tr_b16 a[34:35], v28 offset:33792
    ds_read_b64_tr_b16 a[36:37], v29 offset:32768
    v_mul_f32 v122, v122, |v122|
    v_mul_f32 v123, v123, |v123|
    buffer_load_dwordx4 v60, s[48:51], s16 offen offset:1024 sc1 lds
    s_add_u32 m0, s66, 37376
    s_waitcnt lgkmcnt(7)
    v_mfma_f32_32x32x16_bf16 a[224:239], a[200:203], a[204:207], a[224:239]
    v_mul_f32 v124, v124, |v124|
    v_mul_f32 v125, v125, |v125|
    v_mul_f32 v126, v126, |v126|
    v_mul_f32 v127, v127, |v127|
    v_cvt_pk_bf16_f32 v120, v120, v121
    v_cvt_pk_bf16_f32 v121, v122, v123
    ds_read_b64_tr_b16 a[38:39], v29 offset:33792
    ds_read_b64_tr_b16 a[40:41], v28 offset:34816
    ds_read_b64_tr_b16 a[42:43], v28 offset:35840
    s_waitcnt lgkmcnt(8)
    v_mfma_f32_32x32x16_bf16 a[224:239], a[208:211], a[212:215], a[224:239]
    v_cvt_pk_bf16_f32 v122, v124, v125
    buffer_load_dwordx4 v26, s[44:47], s70 offen offset:2048 lds
    s_add_u32 m0, s17, 4224
    v_cvt_pk_bf16_f32 v123, v126, v127
    v_pk_max_i16 v120, v120, 0
    v_pk_max_i16 v121, v121, 0
    ds_read_b64_tr_b16 a[44:45], v29 offset:34816
    ds_read_b64_tr_b16 a[46:47], v29 offset:35840
    v_pk_max_i16 v122, v122, 0
    v_pk_max_i16 v123, v123, 0
    buffer_load_dwordx4 v60, s[48:51], s16 offen offset:2048 sc1 lds
    s_add_u32 m0, s66, 37376
    s_waitcnt lgkmcnt(8)
    v_mfma_f32_32x32x16_bf16 a[224:239], a[216:219], a[220:223], a[224:239]
    buffer_store_dwordx4 v[120:123], v60, s[48:51], s3 offen offset:3072 sc1
    ds_write_b64 v244, v[240:241] offset:0
    ds_write_b128 v245, v[240:243]
    v_min_u32 v61, 6, v1
    v_lshlrev_b32 v61, 7, v61
    v_mov_b32 v10, 1
    buffer_load_dwordx4 v27, s[44:47], s70 offen offset:3072 lds
    s_add_u32 m0, s17, 4224
    s_add_u32 s64, s64, 28672
    s_cmp_eq_u32 s64, 401408
    s_cselect_b32 s64, 0, s64
    s_mov_b32 exec_lo, 0x1fffff
    s_mov_b32 exec_hi, 0x1fffff
    ds_write_b128 v178, a[224:227] offset:0
    ds_write_b128 v178, a[228:231] offset:32
    ds_write_b128 v178, a[232:235] offset:64
    ds_write_b128 v178, a[236:239] offset:96
    s_mov_b64 exec, -1
    s_waitcnt lgkmcnt(0)
    s_barrier
    ds_read2st64_b32 v[192:193], v170 offset0:0 offset1:53
    ds_read2st64_b32 v[194:195], v171 offset0:0 offset1:53
    ds_read2st64_b32 v[196:197], v172 offset0:0 offset1:53
    buffer_load_dwordx4 v60, s[48:51], s16 offen offset:3072 sc1 lds
    s_add_u32 m0, s66, 66048
    ds_read2st64_b32 v[198:199], v173 offset0:0 offset1:53
    ds_read2st64_b32 v[200:201], v174 offset0:0 offset1:53
    ds_read2st64_b32 v[202:203], v175 offset0:0 offset1:53
    ds_read2st64_b32 v[204:205], v176 offset0:0 offset1:53
    ds_read2st64_b32 v[206:207], v177 offset0:0 offset1:53
    ds_read2st64_b32 v[208:209], v170 offset0:106 offset1:159
    ds_read2st64_b32 v[210:211], v171 offset0:106 offset1:159
    ds_read2st64_b32 v[212:213], v172 offset0:106 offset1:159
    ds_read2st64_b32 v[214:215], v173 offset0:106 offset1:159
    s_add_u32 s70, s18, s64
    buffer_load_dwordx4 v24, s[44:47], s70 offen offset:0 lds
    ds_read2st64_b32 v[216:217], v174 offset0:106 offset1:159
    ds_read2st64_b32 v[218:219], v175 offset0:106 offset1:159
    ds_read2st64_b32 v[220:221], v176 offset0:106 offset1:159
    ds_read2st64_b32 v[222:223], v177 offset0:106 offset1:159
    s_waitcnt vmcnt(3)
    s_and_b32 s67, s56, 1
    s_lshl1_add_u32 s67, s57, s67
    s_lshl4_add_u32 s67, s67, s58
    s_lshr_b32 s68, s56, 1
    s_lshl1_add_u32 s67, s67, s68
    s_lshl_b32 s67, s67, 7
    s_add_u32 s67, s67, 14680064
    s_mov_b64 exec, 1
    v_mov_b32 v63, 0
    buffer_store_dword v250, v63, s[48:51], s67 offen sc1
    s_mov_b64 exec, -1
    ds_read_b64_tr_b16 a[48:49], v28 offset:36864
    ds_read_b64_tr_b16 a[50:51], v28 offset:37888
    ds_read_b64_tr_b16 a[52:53], v29 offset:36864
    s_waitcnt lgkmcnt(14)
    v_add_f32 v192, v192, v193
    s_waitcnt lgkmcnt(14)
    v_add_f32 v194, v194, v195
    buffer_load_dwordx4 v25, s[44:47], s70 offen offset:1024 lds
    s_waitcnt lgkmcnt(14)
    v_add_f32 v196, v196, v197
    s_waitcnt lgkmcnt(14)
    v_add_f32 v198, v198, v199
    s_waitcnt lgkmcnt(14)
    v_add_f32 v200, v200, v201
    ds_read_b64_tr_b16 a[54:55], v29 offset:37888
    ds_read_b64_tr_b16 a[56:57], v28 offset:38912
    ds_read_b64_tr_b16 a[58:59], v28 offset:39936
    s_waitcnt lgkmcnt(14)
    v_add_f32 v202, v202, v203
    s_waitcnt lgkmcnt(14)
    v_add_f32 v204, v204, v205
    buffer_load_dwordx4 v26, s[44:47], s70 offen offset:2048 lds
    s_waitcnt lgkmcnt(14)
    v_add_f32 v206, v206, v207
    v_cvt_pk_bf16_f32 v192, v192, v194
    v_cvt_pk_bf16_f32 v193, v196, v198
    ds_read_b64_tr_b16 a[60:61], v29 offset:38912
    ds_read_b64_tr_b16 a[62:63], v29 offset:39936
    v_cvt_pk_bf16_f32 v194, v200, v202
    v_cvt_pk_bf16_f32 v195, v204, v206
    ds_write_b128 v9, v[192:195] offset:0
    s_waitcnt lgkmcnt(14)
    v_add_f32 v208, v208, v209
    buffer_load_dwordx4 v27, s[44:47], s70 offen offset:3072 lds
    s_add_u32 m0, s66, 70144
    s_add_u32 s64, s64, 28672
    s_waitcnt lgkmcnt(14)
    v_add_f32 v210, v210, v211
    s_waitcnt lgkmcnt(14)
    v_add_f32 v212, v212, v213
    s_waitcnt lgkmcnt(13)
    v_add_f32 v214, v214, v215
    s_waitcnt lgkmcnt(12)
    v_add_f32 v216, v216, v217
    s_waitcnt lgkmcnt(11)
    v_add_f32 v218, v218, v219
    s_waitcnt lgkmcnt(1)
    s_add_u32 s70, s18, s64
    buffer_load_dwordx4 v24, s[44:47], s70 offen offset:0 lds
    v_add_f32 v220, v220, v221
    v_add_f32 v222, v222, v223
    v_cvt_pk_bf16_f32 v208, v208, v210
    v_cvt_pk_bf16_f32 v209, v212, v214
    v_cvt_pk_bf16_f32 v210, v216, v218
    buffer_load_dwordx4 v25, s[44:47], s70 offen offset:1024 lds
    v_cvt_pk_bf16_f32 v211, v220, v222
    ds_write_b128 v9, v[208:211] offset:4608
    buffer_load_dwordx4 v26, s[44:47], s70 offen offset:2048 lds
    buffer_load_dwordx4 v27, s[44:47], s70 offen offset:3072 lds
    s_add_u32 m0, s66, 33280
    s_add_u32 s64, s64, 28672
    s_cmp_eq_u32 s64, 401408
    s_cselect_b32 s64, 0, s64
    s_add_u32 s64, s64, 57344
    s_cmp_eq_u32 s64, 401408
    s_cselect_b32 s64, 0, s64
    s_add_u32 s11, s18, s64
    s_add_u32 s12, s11, 28672
    s_add_u32 s64, s64, 57344
    s_cmp_eq_u32 s64, 401408
    s_cselect_b32 s64, 0, s64
    s_add_u32 s13, s18, s64
    s_add_u32 s14, s13, 28672
    v_and_b32 v2, 31, v1
    v_lshrrev_b32 v3, 5, v1
    s_lshl_b32 s68, s60, 7
    v_lshl_add_u32 v63, v2, 1, s68
    global_load_ushort v20, v63, s[26:27]
    s_lshl_b32 s67, s56, 5
    v_lshl_add_u32 v13, v3, 4, s67
    global_load_ushort v21, v63, s[26:27] offset:64
    s_lshl_b32 s67, s59, 8
    s_add_u32 s67, s67, 2097152
    buffer_load_dwordx4 v[32:35], v13, s[48:51], s67 offen sc1
    buffer_load_dwordx4 v[36:39], v13, s[48:51], s67 offen offset:128 sc1
    ds_read_b64_tr_b16 a[64:65], v28 offset:0
    ds_read_b64_tr_b16 a[66:67], v28 offset:1024
    ds_read_b64_tr_b16 a[68:69], v29 offset:0
    ds_read_b64_tr_b16 a[70:71], v29 offset:1024
    ds_read_b64_tr_b16 a[72:73], v28 offset:2048
    ds_read_b64_tr_b16 a[74:75], v28 offset:3072
    ds_read_b64_tr_b16 a[76:77], v29 offset:2048
    ds_read_b64_tr_b16 a[78:79], v29 offset:3072
    s_waitcnt vmcnt(13) lgkmcnt(8)
    s_barrier
    ds_read_b128 v[160:163], v5 offset:3584
    ds_read_b64 v[128:129], v4 offset:0
    ds_read_b64 v[130:131], v4 offset:8
    ds_read_b128 v[164:167], v5 offset:3072
    ds_read_b64 v[132:133], v4 offset:512
    ds_read_b64 v[134:135], v4 offset:520
    ds_read_b128 v[168:171], v5 offset:2560
    ds_read_b64 v[136:137], v4 offset:1024
    ds_read_b64 v[138:139], v4 offset:1032
    ds_read_b128 v[172:175], v5 offset:2048
    ds_read_b64 v[140:141], v4 offset:1536
    ds_read_b64 v[142:143], v4 offset:1544
    s_waitcnt lgkmcnt(9)
    v_mfma_f32_16x16x32_bf16 a[224:227], v[128:131], v[160:163], 0
    ds_read_b128 v[176:179], v5 offset:1536
    s_waitcnt lgkmcnt(9)
    v_mfma_f32_16x16x32_bf16 a[228:231], v[128:131], v[164:167], 0
    buffer_load_dwordx4 v24, s[44:47], s11 offen offset:0 lds
    s_waitcnt lgkmcnt(7)
    v_mfma_f32_16x16x32_bf16 a[232:235], v[132:135], v[164:167], 0
    ds_read_b64 v[144:145], v4 offset:2048
    ds_read_b64 v[146:147], v4 offset:2056
    v_mfma_f32_16x16x32_bf16 a[228:231], v[132:135], v[160:163], a[228:231]
    ds_read_b64_tr_b16 a[80:81], v28 offset:4096
    s_waitcnt lgkmcnt(9)
    v_mfma_f32_16x16x32_bf16 a[232:235], v[128:131], v[168:171], a[232:235]
    ds_read_b64_tr_b16 a[82:83], v28 offset:5120
    ds_read_b64_tr_b16 a[84:85], v29 offset:4096
    v_mfma_f32_16x16x32_bf16 a[236:239], v[132:135], v[168:171], 0
    buffer_load_dwordx4 v25, s[44:47], s11 offen offset:1024 lds
    s_waitcnt lgkmcnt(9)
    v_mfma_f32_16x16x32_bf16 a[240:243], v[136:139], v[168:171], 0
    ds_read_b64_tr_b16 a[86:87], v29 offset:5120
    v_mfma_f32_16x16x32_bf16 a[232:235], v[136:139], v[160:163], a[232:235]
    ds_read_b64_tr_b16 a[88:89], v28 offset:6144
    ds_read_b64_tr_b16 a[90:91], v28 offset:7168
    v_mfma_f32_16x16x32_bf16 a[236:239], v[136:139], v[164:167], a[236:239]
    ds_read_b64_tr_b16 a[92:93], v29 offset:6144
    s_waitcnt lgkmcnt(12)
    v_mfma_f32_16x16x32_bf16 a[236:239], v[128:131], v[172:175], a[236:239]
    buffer_load_dwordx4 v26, s[44:47], s11 offen offset:2048 lds
    v_mfma_f32_16x16x32_bf16 a[240:243], v[132:135], v[172:175], a[240:243]
    ds_read_b64_tr_b16 a[94:95], v29 offset:7168
    v_mfma_f32_16x16x32_bf16 a[244:247], v[136:139], v[172:175], 0
    ds_read_b128 v[180:183], v5 offset:1024
    ds_read_b64 v[148:149], v4 offset:2560
    s_waitcnt lgkmcnt(13)
    v_mfma_f32_16x16x32_bf16 a[248:251], v[140:143], v[172:175], 0
    ds_read_b64 v[150:151], v4 offset:2568
    v_mfma_f32_16x16x32_bf16 a[236:239], v[140:143], v[160:163], a[236:239]
    buffer_load_dwordx4 v27, s[44:47], s11 offen offset:3072 lds
    s_add_u32 m0, s66, 37376
    v_mfma_f32_16x16x32_bf16 a[240:243], v[140:143], v[164:167], a[240:243]
    ds_read_b128 v[184:187], v5 offset:512
    ds_read_b64 v[152:153], v4 offset:3072
    v_mfma_f32_16x16x32_bf16 a[244:247], v[140:143], v[168:171], a[244:247]
    ds_read_b64 v[154:155], v4 offset:3080
    s_waitcnt lgkmcnt(14)
    v_mfma_f32_16x16x32_bf16 a[240:243], v[128:131], v[176:179], a[240:243]
    ds_read_b128 v[188:191], v5 offset:0
    v_mfma_f32_16x16x32_bf16 a[244:247], v[132:135], v[176:179], a[244:247]
    s_waitcnt lgkmcnt(7)
    buffer_load_dwordx4 v24, s[44:47], s12 offen offset:0 lds
    v_mfma_f32_16x16x32_bf16 a[248:251], v[136:139], v[176:179], a[248:251]
    ds_read_b64 v[156:157], v4 offset:3584
    ds_read_b64 v[158:159], v4 offset:3592
    v_mfma_f32_16x16x32_bf16 a[252:255], v[140:143], v[176:179], 0
    ds_read_b128 v[224:227], v5 offset:3648
    v_mfma_f32_16x16x32_bf16 a[240:243], v[144:147], v[160:163], a[240:243]
    ds_read_b64 v[192:193], v4 offset:64
    ds_read_b64 v[194:195], v4 offset:72
    v_mfma_f32_16x16x32_bf16 a[244:247], v[144:147], v[164:167], a[244:247]
    buffer_load_dwordx4 v25, s[44:47], s12 offen offset:1024 lds
    v_mfma_f32_16x16x32_bf16 a[248:251], v[144:147], v[168:171], a[248:251]
    ds_read_b128 v[228:231], v5 offset:3136
    v_mfma_f32_16x16x32_bf16 a[252:255], v[144:147], v[172:175], a[252:255]
    ds_read_b64 v[196:197], v4 offset:576
    ds_read_b64 v[198:199], v4 offset:584
    s_waitcnt lgkmcnt(14)
    v_mfma_f32_16x16x32_bf16 a[244:247], v[128:131], v[180:183], a[244:247]
    ds_read_b128 v[232:235], v5 offset:2624
    v_mfma_f32_16x16x32_bf16 a[248:251], v[132:135], v[180:183], a[248:251]
    buffer_load_dwordx4 v26, s[44:47], s12 offen offset:2048 lds
    v_mfma_f32_16x16x32_bf16 a[252:255], v[136:139], v[180:183], a[252:255]
    ds_read_b64 v[200:201], v4 offset:1088
    s_waitcnt lgkmcnt(14)
    v_mfma_f32_16x16x32_bf16 a[244:247], v[148:151], v[160:163], a[244:247]
    ds_read_b64 v[202:203], v4 offset:1096
    s_waitcnt vmcnt(15)
    ds_read_b64_tr_b16 a[96:97], v28 offset:32768
    v_mfma_f32_16x16x32_bf16 a[248:251], v[148:151], v[164:167], a[248:251]
    ds_read_b64_tr_b16 a[98:99], v28 offset:33792
    v_mfma_f32_16x16x32_bf16 a[252:255], v[148:151], v[168:171], a[252:255]
    buffer_load_dwordx4 v27, s[44:47], s12 offen offset:3072 lds
    s_add_u32 m0, s66, 66048
    s_waitcnt lgkmcnt(14)
    v_mfma_f32_16x16x32_bf16 a[248:251], v[128:131], v[184:187], a[248:251]
    ds_read_b64_tr_b16 a[100:101], v29 offset:32768
    ds_read_b64_tr_b16 a[102:103], v29 offset:33792
    v_mfma_f32_16x16x32_bf16 a[252:255], v[132:135], v[184:187], a[252:255]
    ds_read_b64_tr_b16 a[104:105], v28 offset:34816
    s_waitcnt lgkmcnt(14)
    v_mfma_f32_16x16x32_bf16 a[248:251], v[152:155], v[160:163], a[248:251]
    ds_read_b64_tr_b16 a[106:107], v28 offset:35840
    ds_read_b64_tr_b16 a[108:109], v29 offset:34816
    s_waitcnt lgkmcnt(14)
    v_mfma_f32_16x16x32_bf16 a[252:255], v[128:131], v[188:191], a[252:255]
    buffer_load_dword v62, v61, s[48:51], s15 offen sc1
    v_mfma_f32_16x16x32_bf16 a[252:255], v[152:155], v[164:167], a[252:255]
    ds_read_b64_tr_b16 a[110:111], v29 offset:35840
    s_waitcnt lgkmcnt(14)
    v_mfma_f32_16x16x32_bf16 a[252:255], v[156:159], v[160:163], a[252:255]
    ds_read_b128 v[236:239], v5 offset:2112
    s_waitcnt lgkmcnt(14)
    v_mfma_f32_16x16x32_bf16 a[224:227], v[192:195], v[224:227], a[224:227]
    ds_read_b64 v[204:205], v4 offset:1600
    s_waitcnt lgkmcnt(14)
    v_mfma_f32_16x16x32_bf16 a[228:231], v[192:195], v[228:231], a[228:231]
    s_waitcnt lgkmcnt(2)
    buffer_load_dwordx4 v24, s[44:47], s13 offen offset:0 lds
    v_mfma_f32_16x16x32_bf16 a[232:235], v[196:199], v[228:231], a[232:235]
    ds_read_b64 v[206:207], v4 offset:1608
    ds_read_b128 v[240:243], v5 offset:1600
    v_mfma_f32_16x16x32_bf16 a[228:231], v[196:199], v[224:227], a[228:231]
    ds_read_b64 v[208:209], v4 offset:2112
    v_mfma_f32_16x16x32_bf16 a[232:235], v[192:195], v[232:235], a[232:235]
    ds_read_b64 v[210:211], v4 offset:2120
    v_mfma_f32_16x16x32_bf16 a[236:239], v[196:199], v[232:235], a[236:239]
    buffer_load_dwordx4 v25, s[44:47], s13 offen offset:1024 lds
    v_mfma_f32_16x16x32_bf16 a[240:243], v[200:203], v[232:235], a[240:243]
    s_waitcnt vmcnt(15)
    ds_read_b64_tr_b16 a[112:113], v28 offset:36864
    v_mfma_f32_16x16x32_bf16 a[232:235], v[200:203], v[224:227], a[232:235]
    ds_read_b64_tr_b16 a[114:115], v28 offset:37888
    ds_read_b64_tr_b16 a[116:117], v29 offset:36864
    v_mfma_f32_16x16x32_bf16 a[236:239], v[200:203], v[228:231], a[236:239]
    ds_read_b64_tr_b16 a[118:119], v29 offset:37888
    s_waitcnt lgkmcnt(9)
    v_mfma_f32_16x16x32_bf16 a[236:239], v[192:195], v[236:239], a[236:239]
    buffer_load_dwordx4 v26, s[44:47], s13 offen offset:2048 lds
    v_mfma_f32_16x16x32_bf16 a[240:243], v[196:199], v[236:239], a[240:243]
    ds_read_b64_tr_b16 a[120:121], v28 offset:38912
    v_mfma_f32_16x16x32_bf16 a[244:247], v[200:203], v[236:239], a[244:247]
    ds_read_b64_tr_b16 a[122:123], v28 offset:39936
    s_waitcnt lgkmcnt(9)
    v_mfma_f32_16x16x32_bf16 a[248:251], v[204:207], v[236:239], a[248:251]
    ds_read_b64_tr_b16 a[124:125], v29 offset:38912
    ds_read_b64_tr_b16 a[126:127], v29 offset:39936
    v_mfma_f32_16x16x32_bf16 a[236:239], v[204:207], v[224:227], a[236:239]
    buffer_load_dwordx4 v27, s[44:47], s13 offen offset:3072 lds
    s_add_u32 m0, s66, 70144
    v_mfma_f32_16x16x32_bf16 a[240:243], v[204:207], v[228:231], a[240:243]
    ds_read_b128 v[244:247], v5 offset:1088
    v_mfma_f32_16x16x32_bf16 a[244:247], v[204:207], v[232:235], a[244:247]
    ds_read_b64 v[212:213], v4 offset:2624
    s_waitcnt lgkmcnt(12)
    v_mfma_f32_16x16x32_bf16 a[240:243], v[192:195], v[240:243], a[240:243]
    ds_read_b64 v[214:215], v4 offset:2632
    v_mfma_f32_16x16x32_bf16 a[244:247], v[196:199], v[240:243], a[244:247]
    s_waitcnt lgkmcnt(3)
    buffer_load_dwordx4 v24, s[44:47], s14 offen offset:0 lds
    v_mfma_f32_16x16x32_bf16 a[248:251], v[200:203], v[240:243], a[248:251]
    ds_read_b128 v[248:251], v5 offset:576
    v_mfma_f32_16x16x32_bf16 a[252:255], v[204:207], v[240:243], a[252:255]
    ds_read_b64 v[216:217], v4 offset:3136
    ds_read_b64 v[218:219], v4 offset:3144
    v_mfma_f32_16x16x32_bf16 a[240:243], v[208:211], v[224:227], a[240:243]
    ds_read_b128 v[252:255], v5 offset:64
    v_mfma_f32_16x16x32_bf16 a[244:247], v[208:211], v[228:231], a[244:247]
    buffer_load_dwordx4 v25, s[44:47], s14 offen offset:1024 lds
    v_mfma_f32_16x16x32_bf16 a[248:251], v[208:211], v[232:235], a[248:251]
    ds_read_b64 v[220:221], v4 offset:3648
    v_mfma_f32_16x16x32_bf16 a[252:255], v[208:211], v[236:239], a[252:255]
    ds_read_b64 v[222:223], v4 offset:3656
    s_waitcnt lgkmcnt(8)
    v_mfma_f32_16x16x32_bf16 a[244:247], v[192:195], v[244:247], a[244:247]
    ds_read_b128 v[160:163], v5 offset:3712
    ds_read_b64 v[128:129], v4 offset:128
    v_mfma_f32_16x16x32_bf16 a[248:251], v[196:199], v[244:247], a[248:251]
    buffer_load_dwordx4 v26, s[44:47], s14 offen offset:2048 lds
    v_mfma_f32_16x16x32_bf16 a[252:255], v[200:203], v[244:247], a[252:255]
    ds_read_b64 v[130:131], v4 offset:136
    s_waitcnt lgkmcnt(9)
    v_mfma_f32_16x16x32_bf16 a[244:247], v[212:215], v[224:227], a[244:247]
    ds_read_b128 v[164:167], v5 offset:3200
    v_mfma_f32_16x16x32_bf16 a[248:251], v[212:215], v[228:231], a[248:251]
    ds_read_b64 v[132:133], v4 offset:640
    v_mfma_f32_16x16x32_bf16 a[252:255], v[212:215], v[232:235], a[252:255]
    buffer_load_dwordx4 v27, s[44:47], s14 offen offset:3072 lds
    s_waitcnt lgkmcnt(10)
    v_mfma_f32_16x16x32_bf16 a[248:251], v[192:195], v[248:251], a[248:251]
    ds_read_b64 v[134:135], v4 offset:648
    ds_read_b128 v[168:171], v5 offset:2688
    v_mfma_f32_16x16x32_bf16 a[252:255], v[196:199], v[248:251], a[252:255]
    ds_read_b64 v[136:137], v4 offset:1152
    s_waitcnt lgkmcnt(11)
    v_mfma_f32_16x16x32_bf16 a[248:251], v[216:219], v[224:227], a[248:251]
    ds_read_b64 v[138:139], v4 offset:1160
    s_waitcnt lgkmcnt(11)
    v_mfma_f32_16x16x32_bf16 a[252:255], v[192:195], v[252:255], a[252:255]
    s_waitcnt vmcnt(8)
    v_cmp_eq_u32 vcc, 0, v62
    s_cbranch_vccnz L_ph_s
L_ph_b:
    buffer_load_dwordx4 v[64:67], v22, s[48:51], s4 offen offset:0 sc1
    v_mfma_f32_16x16x32_bf16 a[252:255], v[216:219], v[228:231], a[252:255]
    ds_read_b128 v[172:175], v5 offset:2176
    s_waitcnt lgkmcnt(10)
    v_mfma_f32_16x16x32_bf16 a[252:255], v[220:223], v[224:227], a[252:255]
    ds_read_b64 v[140:141], v4 offset:1664
    s_waitcnt lgkmcnt(8)
    v_mfma_f32_16x16x32_bf16 a[224:227], v[128:131], v[160:163], a[224:227]
    ds_read_b64 v[142:143], v4 offset:1672
    s_waitcnt lgkmcnt(8)
    v_mfma_f32_16x16x32_bf16 a[228:231], v[128:131], v[164:167], a[228:231]
    buffer_load_dwordx4 v[68:71], v22, s[48:51], s4 offen offset:1024 sc1
    s_waitcnt lgkmcnt(6)
    v_mfma_f32_16x16x32_bf16 a[232:235], v[132:135], v[164:167], a[232:235]
    ds_read_b128 v[176:179], v5 offset:1664
    v_mfma_f32_16x16x32_bf16 a[228:231], v[132:135], v[160:163], a[228:231]
    ds_read_b64 v[144:145], v4 offset:2176
    s_waitcnt lgkmcnt(7)
    v_mfma_f32_16x16x32_bf16 a[232:235], v[128:131], v[168:171], a[232:235]
    ds_read_b64 v[146:147], v4 offset:2184
    v_mfma_f32_16x16x32_bf16 a[236:239], v[132:135], v[168:171], a[236:239]
    buffer_load_dwordx4 v[72:75], v22, s[48:51], s4 offen offset:2048 sc1
    s_waitcnt lgkmcnt(6)
    v_mfma_f32_16x16x32_bf16 a[240:243], v[136:139], v[168:171], a[240:243]
    ds_read_b128 v[180:183], v5 offset:1152
    v_mfma_f32_16x16x32_bf16 a[232:235], v[136:139], v[160:163], a[232:235]
    ds_read_b64 v[148:149], v4 offset:2688
    v_mfma_f32_16x16x32_bf16 a[236:239], v[136:139], v[164:167], a[236:239]
    ds_read_b64 v[150:151], v4 offset:2696
    s_waitcnt lgkmcnt(8)
    v_mfma_f32_16x16x32_bf16 a[236:239], v[128:131], v[172:175], a[236:239]
    buffer_load_dwordx4 v[76:79], v22, s[48:51], s4 offen offset:3072 sc1
    v_mfma_f32_16x16x32_bf16 a[240:243], v[132:135], v[172:175], a[240:243]
    ds_read_b128 v[184:187], v5 offset:640
    v_mfma_f32_16x16x32_bf16 a[244:247], v[136:139], v[172:175], a[244:247]
    ds_read_b64 v[152:153], v4 offset:3200
    s_waitcnt lgkmcnt(8)
    v_mfma_f32_16x16x32_bf16 a[248:251], v[140:143], v[172:175], a[248:251]
    ds_read_b64_tr_b16 a[160:161], v28 offset:0
    v_mfma_f32_16x16x32_bf16 a[236:239], v[140:143], v[160:163], a[236:239]
    buffer_load_dwordx4 v[80:83], v22, s[48:51], s5 offen offset:0 sc1
    v_mfma_f32_16x16x32_bf16 a[240:243], v[140:143], v[164:167], a[240:243]
    ds_read_b64 v[154:155], v4 offset:3208
    v_mfma_f32_16x16x32_bf16 a[244:247], v[140:143], v[168:171], a[244:247]
    ds_read_b128 v[188:191], v5 offset:128
    s_waitcnt lgkmcnt(10)
    v_mfma_f32_16x16x32_bf16 a[240:243], v[128:131], v[176:179], a[240:243]
    ds_read_b64 v[156:157], v4 offset:3712
    v_mfma_f32_16x16x32_bf16 a[244:247], v[132:135], v[176:179], a[244:247]
    buffer_load_dwordx4 v[84:87], v22, s[48:51], s5 offen offset:1024 sc1
    v_mfma_f32_16x16x32_bf16 a[248:251], v[136:139], v[176:179], a[248:251]
    ds_read_b64 v[158:159], v4 offset:3720
    v_mfma_f32_16x16x32_bf16 a[252:255], v[140:143], v[176:179], a[252:255]
    ds_read_b128 v[224:227], v5 offset:3776
    s_waitcnt lgkmcnt(11)
    v_mfma_f32_16x16x32_bf16 a[240:243], v[144:147], v[160:163], a[240:243]
    ds_read_b64 v[192:193], v4 offset:192
    v_mfma_f32_16x16x32_bf16 a[244:247], v[144:147], v[164:167], a[244:247]
    buffer_load_dwordx4 v[88:91], v22, s[48:51], s5 offen offset:2048 sc1
    v_mfma_f32_16x16x32_bf16 a[248:251], v[144:147], v[168:171], a[248:251]
    ds_read_b64_tr_b16 a[162:163], v28 offset:1024
    v_mfma_f32_16x16x32_bf16 a[252:255], v[144:147], v[172:175], a[252:255]
    ds_read_b64 v[194:195], v4 offset:200
    s_waitcnt lgkmcnt(13)
    v_mfma_f32_16x16x32_bf16 a[244:247], v[128:131], v[180:183], a[244:247]
    ds_read_b128 v[228:231], v5 offset:3264
    v_mfma_f32_16x16x32_bf16 a[248:251], v[132:135], v[180:183], a[248:251]
    buffer_load_dwordx4 v[92:95], v22, s[48:51], s5 offen offset:3072 sc1
    v_mfma_f32_16x16x32_bf16 a[252:255], v[136:139], v[180:183], a[252:255]
    ds_read_b64 v[196:197], v4 offset:704
    s_waitcnt lgkmcnt(13)
    v_mfma_f32_16x16x32_bf16 a[244:247], v[148:151], v[160:163], a[244:247]
    ds_read_b64 v[198:199], v4 offset:712
    v_mfma_f32_16x16x32_bf16 a[248:251], v[148:151], v[164:167], a[248:251]
    ds_read_b128 v[232:235], v5 offset:2752
    v_mfma_f32_16x16x32_bf16 a[252:255], v[148:151], v[168:171], a[252:255]
    buffer_load_dwordx4 v[96:99], v22, s[48:51], s6 offen offset:0 sc1
    s_waitcnt lgkmcnt(14)
    v_mfma_f32_16x16x32_bf16 a[248:251], v[128:131], v[184:187], a[248:251]
    ds_read_b64 v[200:201], v4 offset:1216
    v_mfma_f32_16x16x32_bf16 a[252:255], v[132:135], v[184:187], a[252:255]
    ds_read_b64_tr_b16 a[164:165], v29 offset:0
    s_waitcnt lgkmcnt(13)
    v_mfma_f32_16x16x32_bf16 a[248:251], v[152:155], v[160:163], a[248:251]
    ds_read_b64 v[202:203], v4 offset:1224
    s_waitcnt lgkmcnt(13)
    v_mfma_f32_16x16x32_bf16 a[252:255], v[128:131], v[188:191], a[252:255]
    buffer_load_dwordx4 v[100:103], v22, s[48:51], s6 offen offset:1024 sc1
    v_mfma_f32_16x16x32_bf16 a[252:255], v[152:155], v[164:167], a[252:255]
    ds_read_b128 v[236:239], v5 offset:2240
    s_waitcnt lgkmcnt(12)
    v_mfma_f32_16x16x32_bf16 a[252:255], v[156:159], v[160:163], a[252:255]
    ds_read_b64 v[204:205], v4 offset:1728
    s_waitcnt lgkmcnt(9)
    v_mfma_f32_16x16x32_bf16 a[224:227], v[192:195], v[224:227], a[224:227]
    ds_read_b64 v[206:207], v4 offset:1736
    s_waitcnt lgkmcnt(9)
    v_mfma_f32_16x16x32_bf16 a[228:231], v[192:195], v[228:231], a[228:231]
    buffer_load_dwordx4 v[104:107], v22, s[48:51], s6 offen offset:2048 sc1
    s_waitcnt lgkmcnt(7)
    v_mfma_f32_16x16x32_bf16 a[232:235], v[196:199], v[228:231], a[232:235]
    ds_write_b128 v6, a[224:227] offset:0
    v_mfma_f32_16x16x32_bf16 a[228:231], v[196:199], v[224:227], a[228:231]
    ds_read_b128 v[240:243], v5 offset:1728
    s_waitcnt lgkmcnt(8)
    v_mfma_f32_16x16x32_bf16 a[232:235], v[192:195], v[232:235], a[232:235]
    ds_read_b64_tr_b16 a[166:167], v29 offset:1024
    v_mfma_f32_16x16x32_bf16 a[236:239], v[196:199], v[232:235], a[236:239]
    buffer_load_dwordx4 v[108:111], v22, s[48:51], s6 offen offset:3072 sc1
    s_waitcnt lgkmcnt(6)
    v_mfma_f32_16x16x32_bf16 a[240:243], v[200:203], v[232:235], a[240:243]
    ds_write_b128 v6, a[228:231] offset:1280
    v_mfma_f32_16x16x32_bf16 a[232:235], v[200:203], v[224:227], a[232:235]
    ds_read_b64 v[208:209], v4 offset:2240
    v_mfma_f32_16x16x32_bf16 a[236:239], v[200:203], v[228:231], a[236:239]
    ds_read_b64 v[210:211], v4 offset:2248
    s_waitcnt lgkmcnt(8)
    v_mfma_f32_16x16x32_bf16 a[236:239], v[192:195], v[236:239], a[236:239]
    buffer_load_dwordx4 v[112:115], v22, s[48:51], s7 offen offset:0 sc1
    v_mfma_f32_16x16x32_bf16 a[240:243], v[196:199], v[236:239], a[240:243]
    ds_write_b128 v6, a[232:235] offset:2560
    v_mfma_f32_16x16x32_bf16 a[244:247], v[200:203], v[236:239], a[244:247]
    ds_read_b128 v[244:247], v5 offset:1216
    s_waitcnt lgkmcnt(8)
    v_mfma_f32_16x16x32_bf16 a[248:251], v[204:207], v[236:239], a[248:251]
    ds_read_b64 v[212:213], v4 offset:2752
    v_mfma_f32_16x16x32_bf16 a[236:239], v[204:207], v[224:227], a[236:239]
    buffer_load_dwordx4 v[116:119], v22, s[48:51], s7 offen offset:1024 sc1
    v_mfma_f32_16x16x32_bf16 a[240:243], v[204:207], v[228:231], a[240:243]
    ds_read_b64 v[214:215], v4 offset:2760
    v_mfma_f32_16x16x32_bf16 a[244:247], v[204:207], v[232:235], a[244:247]
    ds_write_b128 v6, a[236:239] offset:3840
    s_waitcnt lgkmcnt(9)
    v_mfma_f32_16x16x32_bf16 a[240:243], v[192:195], v[240:243], a[240:243]
    ds_read_b128 v[248:251], v5 offset:704
    v_mfma_f32_16x16x32_bf16 a[244:247], v[196:199], v[240:243], a[244:247]
    buffer_load_dwordx4 v[120:123], v22, s[48:51], s7 offen offset:2048 sc1
    v_mfma_f32_16x16x32_bf16 a[248:251], v[200:203], v[240:243], a[248:251]
    ds_read_b64_tr_b16 a[168:169], v28 offset:2048
    v_mfma_f32_16x16x32_bf16 a[252:255], v[204:207], v[240:243], a[252:255]
    ds_read_b64 v[216:217], v4 offset:3264
    s_waitcnt lgkmcnt(8)
    v_mfma_f32_16x16x32_bf16 a[240:243], v[208:211], v[224:227], a[240:243]
    ds_read_b64 v[218:219], v4 offset:3272
    v_mfma_f32_16x16x32_bf16 a[244:247], v[208:211], v[228:231], a[244:247]
    buffer_load_dwordx4 v[124:127], v22, s[48:51], s7 offen offset:3072 sc1
    v_mfma_f32_16x16x32_bf16 a[248:251], v[208:211], v[232:235], a[248:251]
    ds_write_b128 v6, a[240:243] offset:5120
    v_mfma_f32_16x16x32_bf16 a[252:255], v[208:211], v[236:239], a[252:255]
    ds_read_b128 v[252:255], v5 offset:192
    s_waitcnt lgkmcnt(9)
    v_mfma_f32_16x16x32_bf16 a[244:247], v[192:195], v[244:247], a[244:247]
    ds_read_b64 v[220:221], v4 offset:3776
    v_mfma_f32_16x16x32_bf16 a[248:251], v[196:199], v[244:247], a[248:251]
    buffer_load_dwordx4 v[128:131], v22, s[48:51], s9 offen offset:0 sc1
    v_mfma_f32_16x16x32_bf16 a[252:255], v[200:203], v[244:247], a[252:255]
    ds_read_b64 v[222:223], v4 offset:3784
    s_waitcnt lgkmcnt(9)
    v_mfma_f32_16x16x32_bf16 a[244:247], v[212:215], v[224:227], a[244:247]
    ds_read_b64_tr_b16 a[170:171], v28 offset:3072
    v_mfma_f32_16x16x32_bf16 a[248:251], v[212:215], v[228:231], a[248:251]
    ds_read_b64_tr_b16 a[172:173], v29 offset:2048
    v_mfma_f32_16x16x32_bf16 a[252:255], v[212:215], v[232:235], a[252:255]
    buffer_load_dwordx4 v[132:135], v22, s[48:51], s9 offen offset:1024 sc1
    s_waitcnt lgkmcnt(9)
    v_mfma_f32_16x16x32_bf16 a[248:251], v[192:195], v[248:251], a[248:251]
    ds_write_b128 v6, a[244:247] offset:6400
    v_mfma_f32_16x16x32_bf16 a[252:255], v[196:199], v[248:251], a[252:255]
    ds_read_b64_tr_b16 a[174:175], v29 offset:3072
    s_waitcnt lgkmcnt(8)
    v_mfma_f32_16x16x32_bf16 a[248:251], v[216:219], v[224:227], a[248:251]
    ds_read_b64_tr_b16 a[176:177], v28 offset:4096
    s_waitcnt lgkmcnt(7)
    v_mfma_f32_16x16x32_bf16 a[252:255], v[192:195], v[252:255], a[252:255]
    buffer_load_dwordx4 v[136:139], v22, s[48:51], s9 offen offset:2048 sc1
    v_mfma_f32_16x16x32_bf16 a[252:255], v[216:219], v[228:231], a[252:255]
    ds_write_b128 v6, a[248:251] offset:7680
    s_waitcnt lgkmcnt(6)
    v_mfma_f32_16x16x32_bf16 a[252:255], v[220:223], v[224:227], a[252:255]
    ds_read_b64_tr_b16 a[178:179], v28 offset:5120
    s_waitcnt vmcnt(18)
    v_mfma_f32_32x32x16_bf16 v[192:207], v[64:67], a[128:131], 0
    ds_read_b64_tr_b16 a[180:181], v29 offset:4096
    ds_read_b64_tr_b16 a[182:183], v29 offset:5120
    ds_read_b64_tr_b16 a[184:185], v28 offset:6144
    v_mfma_f32_32x32x16_bf16 v[208:223], v[64:67], a[132:135], 0
    buffer_load_dwordx4 v[140:143], v22, s[48:51], s9 offen offset:3072 sc1
    ds_read_b64_tr_b16 a[186:187], v28 offset:7168
    ds_read_b64_tr_b16 a[188:189], v29 offset:6144
    s_waitcnt vmcnt(18)
    v_mfma_f32_32x32x16_bf16 v[192:207], v[68:71], a[136:139], v[192:207]
    ds_write_b128 v6, a[252:255] offset:8960
    ds_read_b64_tr_b16 a[190:191], v29 offset:7168
    v_mfma_f32_32x32x16_bf16 v[208:223], v[68:71], a[140:143], v[208:223]
    buffer_load_dwordx4 v[144:147], v22, s[48:51], s10 offen offset:0 sc1
    ds_read_b64_tr_b16 a[192:193], v28 offset:32768
    ds_read_b64_tr_b16 a[194:195], v28 offset:33792
    s_waitcnt vmcnt(18)
    v_mfma_f32_32x32x16_bf16 v[192:207], v[72:75], a[144:147], v[192:207]
    s_waitcnt lgkmcnt(3)
    s_barrier
    ds_read_b128 v[224:227], v7 offset:0
    ds_read_b128 v[228:231], v7 offset:10240
    v_mfma_f32_32x32x16_bf16 v[208:223], v[72:75], a[148:151], v[208:223]
    buffer_load_dwordx4 v[148:151], v22, s[48:51], s10 offen offset:1024 sc1
    ds_read_b64_tr_b16 a[196:197], v29 offset:32768
    ds_read_b64_tr_b16 a[198:199], v29 offset:33792
    s_waitcnt vmcnt(18)
    v_mfma_f32_32x32x16_bf16 v[192:207], v[76:79], a[152:155], v[192:207]
    ds_read_b128 v[232:235], v7 offset:20480
    ds_read_b128 v[236:239], v7 offset:30720
    ds_read_b64_tr_b16 a[200:201], v28 offset:34816
    v_mfma_f32_32x32x16_bf16 v[208:223], v[76:79], a[156:159], v[208:223]
    buffer_load_dwordx4 v[152:155], v22, s[48:51], s10 offen offset:2048 sc1
    s_lshl2_add_u32 s67, s2, s56
    s_lshl_b32 s67, s67, 11
    s_waitcnt vmcnt(18)
    v_mfma_f32_32x32x16_bf16 v[192:207], v[80:83], a[32:35], v[192:207]
    ds_read_b128 v[240:243], v7 offset:1280
    ds_read_b128 v[244:247], v7 offset:11520
    s_add_u32 s67, s67, 12582912
    s_waitcnt lgkmcnt(7)
    v_add_f32 v224, v224, v228
    v_mfma_f32_32x32x16_bf16 v[208:223], v[80:83], a[36:39], v[208:223]
    buffer_load_dwordx4 v[156:159], v22, s[48:51], s10 offen offset:3072 sc1
    v_add_f32 v225, v225, v229
    v_add_f32 v226, v226, v230
    s_waitcnt vmcnt(18)
    v_mfma_f32_32x32x16_bf16 v[192:207], v[84:87], a[40:43], v[192:207]
    ds_read_b128 v[248:251], v7 offset:21760
    ds_read_b128 v[252:255], v7 offset:32000
    v_add_f32 v227, v227, v231
    s_waitcnt lgkmcnt(5)
    v_add_f32 v232, v232, v236
    v_mfma_f32_32x32x16_bf16 v[208:223], v[84:87], a[44:47], v[208:223]
    buffer_load_dwordx4 v[160:163], v22, s[48:51], s8 offen offset:0 sc1
    v_add_f32 v233, v233, v237
    v_add_f32 v234, v234, v238
    s_waitcnt vmcnt(18)
    v_mfma_f32_32x32x16_bf16 v[192:207], v[88:91], a[48:51], v[192:207]
    v_add_f32 v235, v235, v239
    v_cvt_pk_bf16_f32 v228, v224, v232
    v_cvt_pk_bf16_f32 v229, v225, v233
    v_cvt_pk_bf16_f32 v230, v226, v234
    v_cvt_pk_bf16_f32 v231, v227, v235
    v_mfma_f32_32x32x16_bf16 v[208:223], v[88:91], a[52:55], v[208:223]
    buffer_load_dwordx4 v[164:167], v22, s[48:51], s8 offen offset:1024 sc1
    ds_read_b64_tr_b16 a[202:203], v28 offset:35840
    ds_read_b64_tr_b16 a[204:205], v29 offset:34816
    s_waitcnt vmcnt(18)
    v_mfma_f32_32x32x16_bf16 v[192:207], v[92:95], a[56:59], v[192:207]
    buffer_store_dwordx4 v[228:231], v60, s[48:51], s67 offen offset:0 sc1
    s_waitcnt lgkmcnt(4)
    v_add_f32 v240, v240, v244
    v_add_f32 v241, v241, v245
    v_mfma_f32_32x32x16_bf16 v[208:223], v[92:95], a[60:63], v[208:223]
    buffer_load_dwordx4 v[168:171], v22, s[48:51], s8 offen offset:2048 sc1
    v_add_f32 v242, v242, v246
    v_add_f32 v243, v243, v247
    s_waitcnt vmcnt(19)
    v_mfma_f32_32x32x16_bf16 v[192:207], v[96:99], a[64:67], v[192:207]
    s_waitcnt lgkmcnt(2)
    v_add_f32 v248, v248, v252
    v_add_f32 v249, v249, v253
    v_add_f32 v250, v250, v254
    v_add_f32 v251, v251, v255
    v_cvt_pk_bf16_f32 v244, v240, v248
    v_mfma_f32_32x32x16_bf16 v[208:223], v[96:99], a[68:71], v[208:223]
    buffer_load_dwordx4 v[172:175], v22, s[48:51], s8 offen offset:3072 sc1
    v_cvt_pk_bf16_f32 v245, v241, v249
    v_cvt_pk_bf16_f32 v246, v242, v250
    s_waitcnt vmcnt(19)
    v_mfma_f32_32x32x16_bf16 v[192:207], v[100:103], a[72:75], v[192:207]
    ds_read_b64_tr_b16 a[206:207], v29 offset:35840
    v_cvt_pk_bf16_f32 v247, v243, v251
    v_mfma_f32_32x32x16_bf16 v[208:223], v[100:103], a[76:79], v[208:223]
    buffer_load_dwordx4 v[176:179], v23, s[48:51], s4 offen offset:0 sc1
    s_waitcnt vmcnt(19)
    v_mfma_f32_32x32x16_bf16 v[192:207], v[104:107], a[80:83], v[192:207]
    buffer_store_dwordx4 v[244:247], v60, s[48:51], s67 offen offset:1024 sc1
    v_mfma_f32_32x32x16_bf16 v[208:223], v[104:107], a[84:87], v[208:223]
    buffer_load_dwordx4 v[180:183], v23, s[48:51], s4 offen offset:1024 sc1
    v_and_b32 v2, 31, v1
    v_lshrrev_b32 v3, 5, v1
    s_waitcnt vmcnt(20)
    v_mfma_f32_32x32x16_bf16 v[192:207], v[108:111], a[88:91], v[192:207]
    ds_write_b128 v30, a[0:3] offset:33280
    s_lshl_b32 s68, s60, 7
    v_lshl_add_u32 v62, v2, 1, s68
    v_mfma_f32_32x32x16_bf16 v[208:223], v[108:111], a[92:95], v[208:223]
    buffer_load_dwordx4 v[184:187], v23, s[48:51], s4 offen offset:2048 sc1
    s_lshl_b32 s67, s56, 5
    v_lshl_add_u32 v13, v3, 4, s67
    s_waitcnt vmcnt(20)
    v_mfma_f32_32x32x16_bf16 v[192:207], v[112:115], a[96:99], v[192:207]
    ds_write_b128 v30, a[4:7] offset:34304
    s_lshl_b32 s58, s59, 8
    s_lshl_b32 s57, s60, 18
    v_mfma_f32_32x32x16_bf16 v[208:223], v[112:115], a[100:103], v[208:223]
    buffer_load_dwordx4 v[188:191], v23, s[48:51], s4 offen offset:3072 sc1
    s_add_u32 s57, s57, s58
    s_add_u32 s57, s57, 12582912
    s_waitcnt vmcnt(20)
    v_mfma_f32_32x32x16_bf16 v[192:207], v[116:119], a[104:107], v[192:207]
    ds_write_b128 v30, a[8:11] offset:35328
    s_add_u32 s58, s58, 2097152
    v_lshl_add_u32 v12, v2, 13, v13
    v_mfma_f32_32x32x16_bf16 v[208:223], v[116:119], a[108:111], v[208:223]
    buffer_load_dwordx4 v[64:67], v23, s[48:51], s5 offen offset:0 sc1
    v_mul_u32_u24 v14, 224, v13
    v_and_b32 v63, 30, v2
    s_waitcnt vmcnt(20)
    v_mfma_f32_32x32x16_bf16 v[192:207], v[120:123], a[112:115], v[192:207]
    ds_write_b128 v30, a[12:15] offset:36352
    ds_read_b64_tr_b16 a[208:209], v28 offset:36864
    v_lshl_add_u32 v14, v63, 1, v14
    v_mfma_f32_32x32x16_bf16 v[208:223], v[120:123], a[116:119], v[208:223]
    buffer_load_dwordx4 v[68:71], v23, s[48:51], s5 offen offset:1024 sc1
    ds_read_b64_tr_b16 a[210:211], v28 offset:37888
    ds_read_b64_tr_b16 a[212:213], v29 offset:36864
    s_waitcnt vmcnt(20)
    v_mfma_f32_32x32x16_bf16 v[192:207], v[124:127], a[120:123], v[192:207]
    ds_read_b64_tr_b16 a[214:215], v29 offset:37888
    ds_read_b64_tr_b16 a[216:217], v28 offset:38912
    ds_read_b64_tr_b16 a[218:219], v28 offset:39936
    v_and_b32 v63, 1, v2
    v_lshl_add_u32 v14, v63, 6, v14
    v_mfma_f32_32x32x16_bf16 v[208:223], v[124:127], a[124:127], v[208:223]
    buffer_load_dwordx4 v[72:75], v23, s[48:51], s5 offen offset:2048 sc1
    ds_read_b64_tr_b16 a[220:221], v29 offset:38912
    ds_read_b64_tr_b16 a[222:223], v29 offset:39936
    s_waitcnt vmcnt(20)
    v_mfma_f32_32x32x16_bf16 v[192:207], v[128:131], a[160:163], v[192:207]
    ds_write_b128 v30, a[16:19] offset:37376
    v_mul_u32_u24 v63, 0x60606, v63
    v_lshl_or_b32 v63, v63, 8, v63
    v_mfma_f32_32x32x16_bf16 v[208:223], v[128:131], a[164:167], v[208:223]
    buffer_load_dwordx4 v[76:79], v23, s[48:51], s5 offen offset:3072 sc1
    v_xor_b32 v15, 0x05040100, v63
    s_mul_i32 s62, s59, 57344
    s_waitcnt vmcnt(20)
    v_mfma_f32_32x32x16_bf16 v[192:207], v[132:135], a[168:171], v[192:207]
    ds_write_b128 v30, a[20:23] offset:38400
    s_add_u32 s62, s62, s68
    s_mul_i32 s67, s56, 6144
    v_mfma_f32_32x32x16_bf16 v[208:223], v[132:135], a[172:175], v[208:223]
    buffer_load_dwordx4 v[80:83], v23, s[48:51], s6 offen offset:0 sc1
    v_add_u32 v19, s67, v60
    s_xor_b32 s67, s56, 1
    s_waitcnt vmcnt(20)
    v_mfma_f32_32x32x16_bf16 v[192:207], v[136:139], a[176:179], v[192:207]
    ds_write_b128 v30, a[24:27] offset:39424
    s_mul_i32 s67, s67, 6144
    v_add_u32 v16, s67, v60
    v_mfma_f32_32x32x16_bf16 v[208:223], v[136:139], a[180:183], v[208:223]
    buffer_load_dwordx4 v[84:87], v23, s[48:51], s6 offen offset:1024 sc1
    s_xor_b32 s67, s56, 2
    s_mul_i32 s67, s67, 6144
    s_waitcnt vmcnt(20)
    v_mfma_f32_32x32x16_bf16 v[192:207], v[140:143], a[184:187], v[192:207]
    ds_write_b128 v30, a[28:31] offset:40448
    ds_read_b64_tr_b16 a[0:1], v28 offset:0
    v_add_u32 v17, s67, v60
    v_mfma_f32_32x32x16_bf16 v[208:223], v[140:143], a[188:191], v[208:223]
    buffer_load_dwordx4 v[88:91], v23, s[48:51], s6 offen offset:2048 sc1
    ds_read_b64_tr_b16 a[2:3], v28 offset:1024
    ds_read_b64_tr_b16 a[4:5], v29 offset:0
    s_waitcnt vmcnt(20)
    v_mfma_f32_32x32x16_bf16 v[192:207], v[144:147], a[192:195], v[192:207]
    ds_read_b64_tr_b16 a[6:7], v29 offset:1024
    ds_read_b64_tr_b16 a[8:9], v28 offset:2048
    ds_read_b64_tr_b16 a[10:11], v28 offset:3072
    s_xor_b32 s67, s56, 3
    s_mul_i32 s67, s67, 6144
    v_mfma_f32_32x32x16_bf16 v[208:223], v[144:147], a[196:199], v[208:223]
    buffer_load_dwordx4 v[92:95], v23, s[48:51], s6 offen offset:3072 sc1
    ds_read_b64_tr_b16 a[12:13], v29 offset:2048
    ds_read_b64_tr_b16 a[14:15], v29 offset:3072
    s_waitcnt vmcnt(20) lgkmcnt(14)
    v_mfma_f32_32x32x16_bf16 v[192:207], v[148:151], a[200:203], v[192:207]
    ds_read_b64_tr_b16 a[16:17], v28 offset:4096
    ds_read_b64_tr_b16 a[18:19], v28 offset:5120
    ds_read_b64_tr_b16 a[20:21], v29 offset:4096
    v_add_u32 v18, s67, v60
    v_lshrrev_b32 v24, 4, v1
    s_waitcnt lgkmcnt(14)
    v_mfma_f32_32x32x16_bf16 v[208:223], v[148:151], a[204:207], v[208:223]
    buffer_load_dwordx4 v[96:99], v23, s[48:51], s7 offen offset:0 sc1
    ds_read_b64_tr_b16 a[22:23], v29 offset:5120
    ds_read_b64_tr_b16 a[24:25], v28 offset:6144
    s_waitcnt vmcnt(20) lgkmcnt(14)
    v_mfma_f32_32x32x16_bf16 v[192:207], v[152:155], a[208:211], v[192:207]
    ds_read_b64_tr_b16 a[26:27], v28 offset:7168
    ds_read_b64_tr_b16 a[28:29], v29 offset:6144
    ds_read_b64_tr_b16 a[30:31], v29 offset:7168
    v_and_b32 v25, 15, v1
    v_xor_b32 v25, v25, v24
    s_waitcnt lgkmcnt(14)
    v_mfma_f32_32x32x16_bf16 v[208:223], v[152:155], a[212:215], v[208:223]
    buffer_load_dwordx4 v[100:103], v23, s[48:51], s7 offen offset:1024 sc1
    s_and_b32 s69, s56, 1
    s_lshl_b32 s69, s69, 3
    s_waitcnt vmcnt(20) lgkmcnt(14)
    v_mfma_f32_32x32x16_bf16 v[192:207], v[156:159], a[216:219], v[192:207]
    v_xor_b32 v25, s69, v25
    v_lshlrev_b32 v24, 13, v24
    v_lshl_add_u32 v24, v25, 4, v24
    v_xor_b32 v25, 64, v24
    v_add_u32 v25, 31744, v25
    s_waitcnt lgkmcnt(14)
    v_mfma_f32_32x32x16_bf16 v[208:223], v[156:159], a[220:223], v[208:223]
    buffer_load_dwordx4 v[104:107], v23, s[48:51], s7 offen offset:2048 sc1
    s_lshl_b32 s69, s56, 16
    s_add_u32 s69, s69, s57
    s_waitcnt vmcnt(20) lgkmcnt(14)
    v_mfma_f32_32x32x16_bf16 v[192:207], v[160:163], a[0:3], v[192:207]
    s_lshl_b32 s70, s56, 11
    s_add_u32 m0, s70, 153088
    v_and_b32 v26, 0xf0, v60
    v_xor_b32 v26, v26, v13
    v_lshl_add_u32 v26, v2, 8, v26
    v_add_u32 v26, 153088, v26
    s_waitcnt lgkmcnt(12)
    v_mfma_f32_32x32x16_bf16 v[208:223], v[160:163], a[4:7], v[208:223]
    buffer_load_dwordx4 v[108:111], v23, s[48:51], s7 offen offset:3072 sc1
    v_xor_b32 v27, 0x80, v26
    s_waitcnt vmcnt(20) lgkmcnt(10)
    v_mfma_f32_32x32x16_bf16 v[192:207], v[164:167], a[8:11], v[192:207]
    s_waitcnt lgkmcnt(8)
    v_mfma_f32_32x32x16_bf16 v[208:223], v[164:167], a[12:15], v[208:223]
    buffer_load_dwordx4 v[112:115], v23, s[48:51], s9 offen offset:0 sc1
    s_waitcnt vmcnt(19) lgkmcnt(6)
    v_mfma_f32_32x32x16_bf16 v[192:207], v[168:171], a[16:19], v[192:207]
    s_waitcnt lgkmcnt(4)
    v_mfma_f32_32x32x16_bf16 v[208:223], v[168:171], a[20:23], v[208:223]
    buffer_load_dwordx4 v[116:119], v23, s[48:51], s9 offen offset:1024 sc1
    s_waitcnt vmcnt(19) lgkmcnt(2)
    v_mfma_f32_32x32x16_bf16 v[192:207], v[172:175], a[24:27], v[192:207]
    s_waitcnt lgkmcnt(0)
    v_mfma_f32_32x32x16_bf16 v[208:223], v[172:175], a[28:31], v[208:223]
    buffer_load_dwordx4 v[120:123], v23, s[48:51], s9 offen offset:2048 sc1
    s_waitcnt vmcnt(19)
    v_mfma_f32_32x32x16_bf16 v[224:239], v[176:179], a[128:131], 0
    v_mfma_f32_32x32x16_bf16 v[240:255], v[176:179], a[132:135], 0
    buffer_load_dwordx4 v[124:127], v23, s[48:51], s9 offen offset:3072 sc1
    ds_write_b128 v16, v[196:199] offset:0
    s_waitcnt vmcnt(18)
    v_mfma_f32_32x32x16_bf16 v[224:239], v[180:183], a[136:139], v[224:239]
    buffer_load_dwordx4 v24, s[48:51], s69 offen offset:0 sc1 lds
    ds_write_b128 v17, v[200:203] offset:2048
    v_mfma_f32_32x32x16_bf16 v[240:255], v[180:183], a[140:143], v[240:255]
    buffer_load_dwordx4 v[128:131], v23, s[48:51], s10 offen offset:0 sc1
    ds_write_b128 v18, v[204:207] offset:4096
    s_waitcnt vmcnt(19)
    v_mfma_f32_32x32x16_bf16 v[224:239], v[184:187], a[144:147], v[224:239]
    buffer_load_dwordx4 v25, s[48:51], s69 offen offset:1024 sc1 lds
    ds_write_b128 v16, v[212:215] offset:1024
    v_mfma_f32_32x32x16_bf16 v[240:255], v[184:187], a[148:151], v[240:255]
    buffer_load_dwordx4 v[132:135], v23, s[48:51], s10 offen offset:1024 sc1
    ds_write_b128 v17, v[216:219] offset:3072
    s_waitcnt vmcnt(20)
    v_mfma_f32_32x32x16_bf16 v[224:239], v[188:191], a[152:155], v[224:239]
    ds_write_b128 v18, v[220:223] offset:5120
    v_mfma_f32_32x32x16_bf16 v[240:255], v[188:191], a[156:159], v[240:255]
    buffer_load_dwordx4 v[136:139], v23, s[48:51], s10 offen offset:2048 sc1
    s_waitcnt vmcnt(20)
    v_mfma_f32_32x32x16_bf16 v[224:239], v[64:67], a[32:35], v[224:239]
    v_mfma_f32_32x32x16_bf16 v[240:255], v[64:67], a[36:39], v[240:255]
    buffer_load_dwordx4 v[140:143], v23, s[48:51], s10 offen offset:3072 sc1
    s_waitcnt vmcnt(20)
    v_mfma_f32_32x32x16_bf16 v[224:239], v[68:71], a[40:43], v[224:239]
    s_waitcnt lgkmcnt(0)
    s_barrier
    ds_read_b128 v[160:163], v19 offset:0
    ds_read_b128 v[164:167], v19 offset:2048
    ds_read_b128 v[168:171], v19 offset:4096
    v_mfma_f32_32x32x16_bf16 v[240:255], v[68:71], a[44:47], v[240:255]
    buffer_load_dwordx4 v[144:147], v23, s[48:51], s8 offen offset:0 sc1
    ds_read_b128 v[172:175], v19 offset:1024
    ds_read_b128 v[176:179], v19 offset:3072
    s_waitcnt vmcnt(20)
    v_mfma_f32_32x32x16_bf16 v[224:239], v[72:75], a[48:51], v[224:239]
    ds_read_b128 v[180:183], v19 offset:5120
    v_mfma_f32_32x32x16_bf16 v[240:255], v[72:75], a[52:55], v[240:255]
    buffer_load_dwordx4 v[148:151], v23, s[48:51], s8 offen offset:1024 sc1
    s_waitcnt vmcnt(20)
    v_mfma_f32_32x32x16_bf16 v[224:239], v[76:79], a[56:59], v[224:239]
    s_waitcnt lgkmcnt(5)
    v_add_f32 v192, v192, v160
    v_add_f32 v193, v193, v161
    v_add_f32 v194, v194, v162
    v_add_f32 v195, v195, v163
    s_waitcnt lgkmcnt(4)
    v_add_f32 v192, v192, v164
    v_mfma_f32_32x32x16_bf16 v[240:255], v[76:79], a[60:63], v[240:255]
    buffer_load_dwordx4 v[152:155], v23, s[48:51], s8 offen offset:2048 sc1
    v_add_f32 v193, v193, v165
    v_add_f32 v194, v194, v166
    v_add_f32 v195, v195, v167
    s_waitcnt vmcnt(20)
    v_mfma_f32_32x32x16_bf16 v[224:239], v[80:83], a[64:67], v[224:239]
    s_waitcnt lgkmcnt(3)
    v_add_f32 v192, v192, v168
    v_add_f32 v193, v193, v169
    v_add_f32 v194, v194, v170
    v_add_f32 v195, v195, v171
    s_waitcnt lgkmcnt(2)
    v_add_f32 v208, v208, v172
    v_mfma_f32_32x32x16_bf16 v[240:255], v[80:83], a[68:71], v[240:255]
    buffer_load_dwordx4 v[156:159], v23, s[48:51], s8 offen offset:3072 sc1
    v_add_f32 v209, v209, v173
    v_add_f32 v210, v210, v174
    v_add_f32 v211, v211, v175
    s_waitcnt vmcnt(20)
    v_mfma_f32_32x32x16_bf16 v[224:239], v[84:87], a[72:75], v[224:239]
    s_waitcnt lgkmcnt(1)
    v_add_f32 v208, v208, v176
    v_add_f32 v209, v209, v177
    v_add_f32 v210, v210, v178
    v_add_f32 v211, v211, v179
    s_waitcnt lgkmcnt(0)
    v_add_f32 v208, v208, v180
    v_mfma_f32_32x32x16_bf16 v[240:255], v[84:87], a[76:79], v[240:255]
    v_add_f32 v209, v209, v181
    v_add_f32 v210, v210, v182
    v_add_f32 v211, v211, v183
    v_lshlrev_b32 v20, 16, v20
    v_lshlrev_b32 v21, 16, v21
    s_waitcnt vmcnt(19)
    v_mfma_f32_32x32x16_bf16 v[224:239], v[88:91], a[80:83], v[224:239]
    v_mfma_f32_32x32x16_bf16 v[240:255], v[88:91], a[84:87], v[240:255]
    s_waitcnt vmcnt(18)
    v_mfma_f32_32x32x16_bf16 v[224:239], v[92:95], a[88:91], v[224:239]
    v_mfma_f32_32x32x16_bf16 v[240:255], v[92:95], a[92:95], v[240:255]
    s_waitcnt vmcnt(17)
    v_mfma_f32_32x32x16_bf16 v[224:239], v[96:99], a[96:99], v[224:239]
    v_mfma_f32_32x32x16_bf16 v[240:255], v[96:99], a[100:103], v[240:255]
    s_waitcnt vmcnt(16)
    v_mfma_f32_32x32x16_bf16 v[224:239], v[100:103], a[104:107], v[224:239]
    v_mfma_f32_32x32x16_bf16 v[240:255], v[100:103], a[108:111], v[240:255]
    s_waitcnt vmcnt(15)
    v_mfma_f32_32x32x16_bf16 v[224:239], v[104:107], a[112:115], v[224:239]
    v_mfma_f32_32x32x16_bf16 v[240:255], v[104:107], a[116:119], v[240:255]
    s_waitcnt vmcnt(14)
    v_mfma_f32_32x32x16_bf16 v[224:239], v[108:111], a[120:123], v[224:239]
    s_waitcnt vmcnt(7)
    s_barrier
    ds_read_b128 v[4:7], v26
    ds_read_b128 v[8:11], v27
    v_mfma_f32_32x32x16_bf16 v[240:255], v[108:111], a[124:127], v[240:255]
    v_mfma_f32_32x32x16_bf16 v[224:239], v[112:115], a[160:163], v[224:239]
    v_mfma_f32_32x32x16_bf16 v[240:255], v[112:115], a[164:167], v[240:255]
    s_waitcnt lgkmcnt(1)
    v_max3_u32 v2, v4, v5, v6
    s_waitcnt lgkmcnt(0)
    v_max3_u32 v3, v7, v8, v9
    v_max3_u32 v2, v2, v10, v11
    v_max_u32 v2, v2, v3
    v_mfma_f32_32x32x16_bf16 v[224:239], v[116:119], a[168:171], v[224:239]
    v_cmp_eq_u32 vcc, -1, v2
    s_cbranch_vccnz L_pa_s
L_pa_b:
    v_and_b32 v40, 0xffff0000, v32
    v_lshlrev_b32 v32, 16, v32
    v_mul_f32 v48, v40, v20
    v_mfma_f32_32x32x16_bf16 v[240:255], v[116:119], a[172:175], v[240:255]
    v_mul_f32 v52, v40, v21
    v_lshlrev_b32 v2, 16, v4
    v_and_b32 v3, 0xffff0000, v4
    v_fmac_f32 v48, v32, v2
    v_fmac_f32 v52, v32, v3
    v_mfma_f32_32x32x16_bf16 v[224:239], v[120:123], a[176:179], v[224:239]
    v_and_b32 v41, 0xffff0000, v33
    v_lshlrev_b32 v33, 16, v33
    v_mul_f32 v49, v41, v20
    v_mul_f32 v53, v41, v21
    v_lshlrev_b32 v2, 16, v5
    v_mfma_f32_32x32x16_bf16 v[240:255], v[120:123], a[180:183], v[240:255]
    v_and_b32 v3, 0xffff0000, v5
    v_fmac_f32 v49, v33, v2
    v_fmac_f32 v53, v33, v3
    v_and_b32 v42, 0xffff0000, v34
    v_lshlrev_b32 v34, 16, v34
    v_mfma_f32_32x32x16_bf16 v[224:239], v[124:127], a[184:187], v[224:239]
    v_mul_f32 v50, v42, v20
    v_mul_f32 v54, v42, v21
    v_lshlrev_b32 v2, 16, v6
    v_and_b32 v3, 0xffff0000, v6
    v_fmac_f32 v50, v34, v2
    v_mfma_f32_32x32x16_bf16 v[240:255], v[124:127], a[188:191], v[240:255]
    v_fmac_f32 v54, v34, v3
    v_and_b32 v43, 0xffff0000, v35
    v_lshlrev_b32 v35, 16, v35
    v_mul_f32 v51, v43, v20
    v_mul_f32 v55, v43, v21
    v_mfma_f32_32x32x16_bf16 v[224:239], v[128:131], a[192:195], v[224:239]
    v_lshlrev_b32 v2, 16, v7
    v_and_b32 v3, 0xffff0000, v7
    v_fmac_f32 v51, v35, v2
    v_fmac_f32 v55, v35, v3
    v_fmac_f32 v48, v192, v40
    v_mfma_f32_32x32x16_bf16 v[240:255], v[128:131], a[196:199], v[240:255]
    v_fmac_f32 v49, v193, v41
    v_fmac_f32 v50, v194, v42
    v_fmac_f32 v51, v195, v43
    v_fmac_f32 v52, v208, v40
    v_fmac_f32 v53, v209, v41
    s_waitcnt vmcnt(6)
    v_mfma_f32_32x32x16_bf16 v[224:239], v[132:135], a[200:203], v[224:239]
    v_fmac_f32 v54, v210, v42
    v_fmac_f32 v55, v211, v43
    v_cvt_pk_bf16_f32 v48, v48, v52
    v_cvt_pk_bf16_f32 v49, v49, v53
    v_cvt_pk_bf16_f32 v50, v50, v54
    v_mfma_f32_32x32x16_bf16 v[240:255], v[132:135], a[204:207], v[240:255]
    v_cvt_pk_bf16_f32 v51, v51, v55
    v_mov_b32_dpp v52, v48 quad_perm:[1,0,3,2] row_mask:0xf bank_mask:0xf
    v_mov_b32_dpp v53, v49 quad_perm:[1,0,3,2] row_mask:0xf bank_mask:0xf
    v_mov_b32_dpp v54, v50 quad_perm:[1,0,3,2] row_mask:0xf bank_mask:0xf
    v_mov_b32_dpp v55, v51 quad_perm:[1,0,3,2] row_mask:0xf bank_mask:0xf
    s_waitcnt vmcnt(5)
    v_mfma_f32_32x32x16_bf16 v[224:239], v[136:139], a[208:211], v[224:239]
    v_perm_b32 v48, v52, v48, v15
    v_mfma_f32_32x32x16_bf16 v[240:255], v[136:139], a[212:215], v[240:255]
    buffer_store_dword v48, v14, s[52:55], s62 offen offset:0 sc1
    v_perm_b32 v49, v53, v49, v15
    s_waitcnt vmcnt(5)
    v_mfma_f32_32x32x16_bf16 v[224:239], v[140:143], a[216:219], v[224:239]
    buffer_store_dword v49, v14, s[52:55], s62 offen offset:896 sc1
    v_perm_b32 v50, v54, v50, v15
    v_mfma_f32_32x32x16_bf16 v[240:255], v[140:143], a[220:223], v[240:255]
    buffer_store_dword v50, v14, s[52:55], s62 offen offset:1792 sc1
    v_perm_b32 v51, v55, v51, v15
    s_waitcnt vmcnt(6)
    v_mfma_f32_32x32x16_bf16 v[224:239], v[144:147], a[0:3], v[224:239]
    buffer_store_dword v51, v14, s[52:55], s62 offen offset:2688 sc1
    s_add_u32 s62, s62, 28672
    v_and_b32 v44, 0xffff0000, v36
    v_lshlrev_b32 v36, 16, v36
    v_mfma_f32_32x32x16_bf16 v[240:255], v[144:147], a[4:7], v[240:255]
    v_mul_f32 v56, v44, v20
    v_mul_f32 v60, v44, v21
    v_lshlrev_b32 v2, 16, v8
    v_and_b32 v3, 0xffff0000, v8
    v_fmac_f32 v56, v36, v2
    s_waitcnt vmcnt(6)
    v_mfma_f32_32x32x16_bf16 v[224:239], v[148:151], a[8:11], v[224:239]
    v_fmac_f32 v60, v36, v3
    v_and_b32 v45, 0xffff0000, v37
    v_lshlrev_b32 v37, 16, v37
    v_mul_f32 v57, v45, v20
    v_mul_f32 v61, v45, v21
    v_mfma_f32_32x32x16_bf16 v[240:255], v[148:151], a[12:15], v[240:255]
    v_lshlrev_b32 v2, 16, v9
    v_and_b32 v3, 0xffff0000, v9
    v_fmac_f32 v57, v37, v2
    v_fmac_f32 v61, v37, v3
    v_and_b32 v46, 0xffff0000, v38
    s_waitcnt vmcnt(5)
    v_mfma_f32_32x32x16_bf16 v[224:239], v[152:155], a[16:19], v[224:239]
    v_lshlrev_b32 v38, 16, v38
    v_mul_f32 v58, v46, v20
    v_mul_f32 v62, v46, v21
    v_lshlrev_b32 v2, 16, v10
    v_and_b32 v3, 0xffff0000, v10
    v_mfma_f32_32x32x16_bf16 v[240:255], v[152:155], a[20:23], v[240:255]
    v_fmac_f32 v58, v38, v2
    v_fmac_f32 v62, v38, v3
    v_and_b32 v47, 0xffff0000, v39
    v_lshlrev_b32 v39, 16, v39
    v_mul_f32 v59, v47, v20
    s_waitcnt vmcnt(4)
    v_mfma_f32_32x32x16_bf16 v[224:239], v[156:159], a[24:27], v[224:239]
    v_mul_f32 v63, v47, v21
    v_lshlrev_b32 v2, 16, v11
    v_and_b32 v3, 0xffff0000, v11
    v_fmac_f32 v59, v39, v2
    v_fmac_f32 v63, v39, v3
    v_mfma_f32_32x32x16_bf16 v[240:255], v[156:159], a[28:31], v[240:255]
    s_nop 3
    ds_write_b128 v16, v[228:231] offset:24576
    ds_write_b128 v17, v[232:235] offset:26624
    ds_write_b128 v18, v[236:239] offset:28672
    s_nop 4
    ds_write_b128 v16, v[244:247] offset:25600
    ds_write_b128 v17, v[248:251] offset:27648
    ds_write_b128 v18, v[252:255] offset:29696
    s_waitcnt lgkmcnt(0)
    s_barrier
    ds_read_b128 v[160:163], v19 offset:24576
    ds_read_b128 v[164:167], v19 offset:26624
    ds_read_b128 v[168:171], v19 offset:28672
    ds_read_b128 v[172:175], v19 offset:25600
    ds_read_b128 v[176:179], v19 offset:27648
    ds_read_b128 v[180:183], v19 offset:29696
    s_waitcnt lgkmcnt(5)
    v_pk_add_f32 v[224:225], v[224:225], v[160:161]
    v_pk_add_f32 v[226:227], v[226:227], v[162:163]
    s_waitcnt lgkmcnt(3)
    v_pk_add_f32 v[164:165], v[164:165], v[168:169]
    v_pk_add_f32 v[166:167], v[166:167], v[170:171]
    v_pk_add_f32 v[224:225], v[224:225], v[164:165]
    v_pk_add_f32 v[226:227], v[226:227], v[166:167]
    s_waitcnt lgkmcnt(2)
    v_pk_add_f32 v[240:241], v[240:241], v[172:173]
    v_pk_add_f32 v[242:243], v[242:243], v[174:175]
    s_waitcnt lgkmcnt(0)
    v_pk_add_f32 v[176:177], v[176:177], v[180:181]
    v_pk_add_f32 v[178:179], v[178:179], v[182:183]
    v_pk_add_f32 v[240:241], v[240:241], v[176:177]
    v_pk_add_f32 v[242:243], v[242:243], v[178:179]
    v_pk_fma_f32 v[56:57], v[224:225], v[44:45], v[56:57]
    v_pk_fma_f32 v[58:59], v[226:227], v[46:47], v[58:59]
    v_pk_fma_f32 v[60:61], v[240:241], v[44:45], v[60:61]
    v_pk_fma_f32 v[62:63], v[242:243], v[46:47], v[62:63]
    v_cvt_pk_bf16_f32 v56, v56, v60
    v_cvt_pk_bf16_f32 v57, v57, v61
    v_cvt_pk_bf16_f32 v58, v58, v62
    v_cvt_pk_bf16_f32 v59, v59, v63
    v_mov_b32_dpp v60, v56 quad_perm:[1,0,3,2] row_mask:0xf bank_mask:0xf
    v_mov_b32_dpp v61, v57 quad_perm:[1,0,3,2] row_mask:0xf bank_mask:0xf
    v_mov_b32_dpp v62, v58 quad_perm:[1,0,3,2] row_mask:0xf bank_mask:0xf
    v_mov_b32_dpp v63, v59 quad_perm:[1,0,3,2] row_mask:0xf bank_mask:0xf
    v_perm_b32 v56, v60, v56, v15
    buffer_store_dword v56, v14, s[52:55], s62 offen offset:0 sc1
    v_perm_b32 v57, v61, v57, v15
    buffer_store_dword v57, v14, s[52:55], s62 offen offset:896 sc1
    v_perm_b32 v58, v62, v58, v15
    buffer_store_dword v58, v14, s[52:55], s62 offen offset:1792 sc1
    v_perm_b32 v59, v63, v59, v15
    buffer_store_dword v59, v14, s[52:55], s62 offen offset:2688 sc1
    s_endpgm
L_other:
    s_add_u32 s2, s2, 256
    s_cmpk_ge_u32 s2, 256
    s_cbranch_scc1 L_end
    v_lshrrev_b32 v2, 6, v0
    v_and_b32 v1, 63, v0
    v_readfirstlane_b32 s56, v2
    s_and_b32 s67, s2, 7
    s_bfe_u32 s68, s2, 0x20003
    s_lshl2_add_u32 s57, s67, s68
    v_lshrrev_b32 v2, 3, v1
    v_and_b32 v3, 7, v1
    v_mul_u32_u24 v4, 896, v2
    v_lshl_add_u32 v4, v3, 4, v4
    s_mul_i32 s67, s57, 57344
    s_lshl_b32 s68, s56, 7
    s_add_u32 s67, s67, s68
    s_mul_i32 s65, s56, 16896
    v_lshl_add_u32 v5, v2, 4, s68
    s_mov_b32 s38, 1835008
    s_mov_b32 s39, 0x00020000
    s_waitcnt lgkmcnt(0)
    s_mov_b64 s[36:37], s[4:5]
    global_load_dwordx4 v[8:11], v5, s[28:29] offset:0
    s_add_u32 m0, s65, 0
    s_add_u32 s69, s67, 0
    buffer_load_dwordx4 v4, s[36:39], s69 offen lds
    s_add_u32 m0, s65, 1056
    s_add_u32 s69, s67, 7168
    buffer_load_dwordx4 v4, s[36:39], s69 offen lds
    s_add_u32 m0, s65, 2112
    s_add_u32 s69, s67, 14336
    buffer_load_dwordx4 v4, s[36:39], s69 offen lds
    s_add_u32 m0, s65, 3168
    s_add_u32 s69, s67, 21504
    buffer_load_dwordx4 v4, s[36:39], s69 offen lds
    s_add_u32 m0, s65, 4224
    s_add_u32 s69, s67, 28672
    buffer_load_dwordx4 v4, s[36:39], s69 offen lds
    s_add_u32 m0, s65, 5280
    s_add_u32 s69, s67, 35840
    buffer_load_dwordx4 v4, s[36:39], s69 offen lds
    s_add_u32 m0, s65, 6336
    s_add_u32 s69, s67, 43008
    buffer_load_dwordx4 v4, s[36:39], s69 offen lds
    s_add_u32 m0, s65, 7392
    s_add_u32 s69, s67, 50176
    buffer_load_dwordx4 v4, s[36:39], s69 offen lds
    s_cmp_eq_u32 s56, 3
    s_cbranch_scc1 L_sp1
    global_load_dwordx4 v[12:15], v5, s[28:29] offset:512
    s_add_u32 m0, s65, 8448
    s_add_u32 s69, s67, 512
    buffer_load_dwordx4 v4, s[36:39], s69 offen lds
    s_add_u32 m0, s65, 9504
    s_add_u32 s69, s67, 7680
    buffer_load_dwordx4 v4, s[36:39], s69 offen lds
    s_add_u32 m0, s65, 10560
    s_add_u32 s69, s67, 14848
    buffer_load_dwordx4 v4, s[36:39], s69 offen lds
    s_add_u32 m0, s65, 11616
    s_add_u32 s69, s67, 22016
    buffer_load_dwordx4 v4, s[36:39], s69 offen lds
    s_add_u32 m0, s65, 12672
    s_add_u32 s69, s67, 29184
    buffer_load_dwordx4 v4, s[36:39], s69 offen lds
    s_add_u32 m0, s65, 13728
    s_add_u32 s69, s67, 36352
    buffer_load_dwordx4 v4, s[36:39], s69 offen lds
    s_add_u32 m0, s65, 14784
    s_add_u32 s69, s67, 43520
    buffer_load_dwordx4 v4, s[36:39], s69 offen lds
    s_add_u32 m0, s65, 15840
    s_add_u32 s69, s67, 50688
    buffer_load_dwordx4 v4, s[36:39], s69 offen lds
L_sp1:
    s_mov_b64 s[48:49], s[34:35]
    s_mov_b32 s50, 20971520
    s_mov_b32 s51, 0x00020000
    v_mul_u32_u24 v6, 1056, v3
    v_lshl_add_u32 v6, v2, 4, v6
    v_add_u32 v6, s65, v6
    v_mul_u32_u24 v7, 33792, v2
    v_lshl_add_u32 v7, v3, 4, v7
    s_mul_i32 s67, s56, 270336
    s_lshl_b32 s68, s57, 7
    s_add_u32 s67, s67, s68
    s_add_u32 s67, s67, 128
    s_mov_b32 s59, 0x05040100
    s_mov_b32 s60, 0x07060302
    s_mov_b32 s58, s56
    v_mov_b32 v80, 0
    v_mov_b32 v81, 0
    v_mov_b32 v82, 0
    v_mov_b32 v83, 0
    v_mov_b32 v84, 0
    v_mov_b32 v85, 0
    v_mov_b32 v86, 0
    v_mov_b32 v87, 0
    v_mov_b32 v48, -1
    v_mov_b32 v49, -1
    v_mov_b32 v50, -1
    v_mov_b32 v51, -1
    v_lshlrev_b32 v4, 4, v1
    v_lshlrev_b32 v5, 7, v1
    s_lshl_b32 s68, s68, 5
    s_add_u32 s68, s68, 14680064
    s_mov_b32 exec_hi, 0
    buffer_store_dword v80, v5, s[48:51], s68 offen sc1
    s_mul_i32 s68, s57, 59136
    s_add_u32 s68, s68, 112
    s_mov_b64 exec, 0x3fff
    v_mul_u32_u24 v5, 4224, v1
    buffer_store_dwordx4 v[80:83], v5, s[48:51], s68 offen sc1
    s_mov_b64 exec, -1
    s_lshl2_add_u32 s68, s57, s56
    s_mul_i32 s68, s68, 14336
    s_add_u32 s68, s68, 12582912
    buffer_store_dwordx4 v[48:51], v4, s[48:51], s68 offen offset:0 sc1
    buffer_store_dwordx4 v[48:51], v4, s[48:51], s68 offen offset:1024 sc1
    buffer_store_dwordx4 v[48:51], v4, s[48:51], s68 offen offset:2048 sc1
    buffer_store_dwordx4 v[48:51], v4, s[48:51], s68 offen offset:3072 sc1
    s_add_u32 s68, s68, 4096
    buffer_store_dwordx4 v[48:51], v4, s[48:51], s68 offen offset:0 sc1
    buffer_store_dwordx4 v[48:51], v4, s[48:51], s68 offen offset:1024 sc1
    buffer_store_dwordx4 v[48:51], v4, s[48:51], s68 offen offset:2048 sc1
    buffer_store_dwordx4 v[48:51], v4, s[48:51], s68 offen offset:3072 sc1
    s_add_u32 s68, s68, 4096
    buffer_store_dwordx4 v[48:51], v4, s[48:51], s68 offen offset:0 sc1
    buffer_store_dwordx4 v[48:51], v4, s[48:51], s68 offen offset:1024 sc1
    buffer_store_dwordx4 v[48:51], v4, s[48:51], s68 offen offset:2048 sc1
    buffer_store_dwordx4 v[48:51], v4, s[48:51], s68 offen offset:3072 sc1
    s_add_u32 s68, s68, 4096
    buffer_store_dwordx4 v[48:51], v4, s[48:51], s68 offen offset:0 sc1
    buffer_store_dwordx4 v[48:51], v4, s[48:51], s68 offen offset:1024 sc1
    s_waitcnt vmcnt(16)
L_sp2:
    ds_read_b128 v[16:19], v6 offset:0
    ds_read_b128 v[20:23], v6 offset:128
    ds_read_b128 v[24:27], v6 offset:256
    ds_read_b128 v[28:31], v6 offset:384
    ds_read_b128 v[32:35], v6 offset:512
    ds_read_b128 v[36:39], v6 offset:640
    ds_read_b128 v[40:43], v6 offset:768
    ds_read_b128 v[44:47], v6 offset:896
    s_waitcnt lgkmcnt(0)
    v_perm_b32 v48, v20, v16, s59
    v_perm_b32 v49, v28, v24, s59
    v_perm_b32 v50, v36, v32, s59
    v_perm_b32 v51, v44, v40, s59
    buffer_store_dwordx4 v[48:51], v7, s[48:51], s67 offen sc1
    s_add_u32 s67, s67, 4224
    v_perm_b32 v52, v20, v16, s60
    v_perm_b32 v53, v28, v24, s60
    v_perm_b32 v54, v36, v32, s60
    v_perm_b32 v55, v44, v40, s60
    buffer_store_dwordx4 v[52:55], v7, s[48:51], s67 offen sc1
    s_add_u32 s67, s67, 4224
    v_perm_b32 v56, v21, v17, s59
    v_perm_b32 v57, v29, v25, s59
    v_perm_b32 v58, v37, v33, s59
    v_perm_b32 v59, v45, v41, s59
    buffer_store_dwordx4 v[56:59], v7, s[48:51], s67 offen sc1
    s_add_u32 s67, s67, 4224
    v_perm_b32 v60, v21, v17, s60
    v_perm_b32 v61, v29, v25, s60
    v_perm_b32 v62, v37, v33, s60
    v_perm_b32 v63, v45, v41, s60
    buffer_store_dwordx4 v[60:63], v7, s[48:51], s67 offen sc1
    s_add_u32 s67, s67, 4224
    v_perm_b32 v64, v22, v18, s59
    v_perm_b32 v65, v30, v26, s59
    v_perm_b32 v66, v38, v34, s59
    v_perm_b32 v67, v46, v42, s59
    buffer_store_dwordx4 v[64:67], v7, s[48:51], s67 offen sc1
    s_add_u32 s67, s67, 4224
    v_perm_b32 v68, v22, v18, s60
    v_perm_b32 v69, v30, v26, s60
    v_perm_b32 v70, v38, v34, s60
    v_perm_b32 v71, v46, v42, s60
    buffer_store_dwordx4 v[68:71], v7, s[48:51], s67 offen sc1
    s_add_u32 s67, s67, 4224
    v_perm_b32 v72, v23, v19, s59
    v_perm_b32 v73, v31, v27, s59
    v_perm_b32 v74, v39, v35, s59
    v_perm_b32 v75, v47, v43, s59
    buffer_store_dwordx4 v[72:75], v7, s[48:51], s67 offen sc1
    s_add_u32 s67, s67, 4224
    v_perm_b32 v76, v23, v19, s60
    v_perm_b32 v77, v31, v27, s60
    v_perm_b32 v78, v39, v35, s60
    v_perm_b32 v79, v47, v43, s60
    buffer_store_dwordx4 v[76:79], v7, s[48:51], s67 offen sc1
    s_add_u32 s67, s67, 4224
    v_dot2c_f32_bf16 v80, v16, v8
    v_dot2c_f32_bf16 v81, v20, v8
    v_dot2c_f32_bf16 v82, v24, v8
    v_dot2c_f32_bf16 v83, v28, v8
    v_dot2c_f32_bf16 v84, v32, v8
    v_dot2c_f32_bf16 v85, v36, v8
    v_dot2c_f32_bf16 v86, v40, v8
    v_dot2c_f32_bf16 v87, v44, v8
    v_dot2c_f32_bf16 v80, v17, v9
    v_dot2c_f32_bf16 v81, v21, v9
    v_dot2c_f32_bf16 v82, v25, v9
    v_dot2c_f32_bf16 v83, v29, v9
    v_dot2c_f32_bf16 v84, v33, v9
    v_dot2c_f32_bf16 v85, v37, v9
    v_dot2c_f32_bf16 v86, v41, v9
    v_dot2c_f32_bf16 v87, v45, v9
    v_dot2c_f32_bf16 v80, v18, v10
    v_dot2c_f32_bf16 v81, v22, v10
    v_dot2c_f32_bf16 v82, v26, v10
    v_dot2c_f32_bf16 v83, v30, v10
    v_dot2c_f32_bf16 v84, v34, v10
    v_dot2c_f32_bf16 v85, v38, v10
    v_dot2c_f32_bf16 v86, v42, v10
    v_dot2c_f32_bf16 v87, v46, v10
    v_dot2c_f32_bf16 v80, v19, v11
    v_dot2c_f32_bf16 v81, v23, v11
    v_dot2c_f32_bf16 v82, v27, v11
    v_dot2c_f32_bf16 v83, v31, v11
    v_dot2c_f32_bf16 v84, v35, v11
    v_dot2c_f32_bf16 v85, v39, v11
    v_dot2c_f32_bf16 v86, v43, v11
    v_dot2c_f32_bf16 v87, v47, v11
    s_add_u32 s67, s67, 1047552
    v_add_u32 v6, 8448, v6
    v_mov_b32 v8, v12
    v_mov_b32 v9, v13
    v_mov_b32 v10, v14
    v_mov_b32 v11, v15
    s_add_u32 s58, s58, 4
    s_cmp_lt_u32 s58, 7
    s_cbranch_scc1 L_sp2
    v_lshlrev_b32 v6, 5, v0
    v_add_u32 v6, 67584, v6
    ds_write_b128 v6, v[80:83]
    ds_write_b128 v6, v[84:87] offset:16
    v_and_b32 v6, 3, v0
    v_lshlrev_b32 v6, 11, v6
    v_and_b32 v4, 0xfc, v0
    v_add_u32 v6, v6, v4
    v_add_u32 v6, 67584, v6
    s_waitcnt lgkmcnt(0)
    s_barrier
    ds_read2st64_b32 v[16:17], v6 offset0:0 offset1:1
    ds_read2st64_b32 v[18:19], v6 offset0:2 offset1:3
    ds_read2st64_b32 v[20:21], v6 offset0:4 offset1:5
    ds_read2st64_b32 v[22:23], v6 offset0:6 offset1:7
    s_waitcnt lgkmcnt(0)
    v_add_f32 v16, v16, v17
    v_add_f32 v18, v18, v19
    v_add_f32 v20, v20, v21
    v_add_f32 v22, v22, v23
    v_add_f32 v16, v16, v18
    v_add_f32 v20, v20, v22
    v_add_f32 v16, v16, v20
    s_nop 1
    v_add_f32_dpp v16, v16, v16 quad_perm:[1,0,3,2] row_mask:0xf bank_mask:0xf
    s_nop 1
    v_add_f32_dpp v16, v16, v16 quad_perm:[2,3,0,1] row_mask:0xf bank_mask:0xf
    v_cvt_pk_bf16_f32 v16, v16, v16
    v_lshlrev_b32 v16, 16, v16
    v_mul_f32 v16, 0xbfb8aa3b, v16
    v_exp_f32 v16, v16
    s_nop 0
    v_add_f32 v16, 1.0, v16
    v_rcp_f32 v16, v16
    s_nop 0
    v_cvt_pk_bf16_f32 v16, v16, v16
    v_lshlrev_b32 v16, 16, v16
    v_sub_f32 v17, 1.0, v16
    v_cvt_pk_bf16_f32 v16, v16, v17
    s_lshl_b32 s67, s57, 8
    s_add_u32 s67, s67, 2097152
    s_mov_b32 exec_lo, 0x11111111
    s_mov_b32 exec_hi, 0x11111111
    buffer_store_dword v16, v4, s[48:51], s67 offen sc1
    s_mov_b64 exec, -1
    s_waitcnt vmcnt(0)
    s_barrier
    s_cmp_lg_u32 s56, 0
    s_cbranch_scc1 L_sp3
    s_lshl_b32 s67, s57, 2
    v_mov_b32 v2, s67
    v_mov_b32 v3, 1
    s_mov_b64 exec, 1
    global_store_dword v2, v3, s[32:33] sc1
    s_mov_b64 exec, -1
L_sp3:
    s_endpgm
L_pu_s:
    s_mov_b32 s99, 0
L_pu_r:
    global_load_dword v250, v61, s[32:33] sc1
    s_waitcnt vmcnt(0)
    v_cmp_eq_u32 vcc, 0, v250
    s_cbranch_vccz L_pu_b
    s_add_u32 s99, s99, 1
    s_cmp_lt_u32 s99, 32768
    s_cbranch_scc1 L_pu_r
    s_branch L_pu_b
L_ph_s:
    s_mov_b32 s99, 0
L_ph_r:
    buffer_load_dword v62, v61, s[48:51], s15 offen sc1
    s_waitcnt vmcnt(0)
    v_cmp_eq_u32 vcc, 0, v62
    s_cbranch_vccz L_ph_b
    s_add_u32 s99, s99, 1
    s_cmp_lt_u32 s99, 32768
    s_cbranch_scc1 L_ph_r
    s_branch L_ph_b
L_pa_s:
    s_mov_b32 s99, 0
L_pa_r:
    buffer_load_dwordx4 v[4:7], v12, s[48:51], s57 offen offset:0 sc1
    buffer_load_dwordx4 v[8:11], v12, s[48:51], s57 offen offset:128 sc1
    s_waitcnt vmcnt(0)
    v_max3_u32 v2, v4, v5, v6
    v_max3_u32 v3, v7, v8, v9
    v_max3_u32 v2, v2, v10, v11
    v_max_u32 v2, v2, v3
    v_cmp_eq_u32 vcc, -1, v2
    s_cbranch_vccz L_pa_b
    s_add_u32 s99, s99, 1
    s_cmp_lt_u32 s99, 32768
    s_cbranch_scc1 L_pa_r
    s_branch L_pa_b
L_end:
    s_endpgm
    .fill (32768 + 64 - (. - gated_mix__ssm_conv_s4d__dense_activation_squared_relu__prompt_kernel)) / 4, 4, 0xbf810000
.section .rodata,"a"
.p2align 6
.amdhsa_kernel gated_mix__ssm_conv_s4d__dense_activation_squared_relu__prompt_kernel
  .amdhsa_next_free_vgpr 512
  .amdhsa_next_free_sgpr 102
  .amdhsa_accum_offset 256
  .amdhsa_group_segment_fixed_size 0
  .amdhsa_kernarg_size 128
  .amdhsa_user_sgpr_count 2
  .amdhsa_user_sgpr_kernarg_segment_ptr 1
  .amdhsa_system_sgpr_workgroup_id_x 1
.end_amdhsa_kernel
```
